```python
import torch

def _softmax(x, axis=-1):
    return torch.softmax(x, dim=axis)
def _gelu(x):
    return torch.nn.functional.gelu(x, approximate="tanh")
def _silu(x):
    return torch.nn.functional.silu(x)
def _sigmoid(x):
    return torch.sigmoid(x)
def _layernorm(x, axis=-1, eps=1e-5):
    m = x.mean(dim=axis, keepdim=True)
    v = x.var(dim=axis, keepdim=True, unbiased=False)
    return (x - m) / torch.sqrt(v + eps)
def _scatter_add(tgt, idx, src, axis=0):
    return tgt.clone().index_add_(axis, idx, src)
def _segment_sum(src, seg, n):
    out = torch.zeros((n,) + src.shape[1:], dtype=src.dtype)
    return out.index_add_(0, seg, src)
def _pad(x, pw):
    flat = tuple(v for pair in reversed(pw) for v in pair)
    return torch.nn.functional.pad(x, flat)

kernel_name = 'recurrent_scan__sliding_local_dilated__dense_activation_silu__prompt'

def setup_inputs():

    _w = (lambda a: (lambda t: t.to(torch.bfloat16) if t.is_floating_point() else t)(torch.as_tensor(a)))
    def _A_setup():
        B, S, D = 1, 2048, 640
        return {
            "x": _w((lambda *s: torch.randn(*s, dtype=torch.bfloat16) * 0.05)(B, S, D)),
            "wqkv": _w((lambda *s: torch.randn(*s, dtype=torch.bfloat16) * 0.2)(D, 3 * D)),
            "wo": _w((lambda *s: torch.randn(*s, dtype=torch.bfloat16) * 0.2)(D, D)),
        }
    _A_in = _A_setup()

    def _B_setup():
        B, S, D, F = 1, 2048, 640, 1536
        return {
            "x": _w((lambda *s: torch.randn(*s, dtype=torch.bfloat16) * 0.05)(B, S, D)),
            "w1": _w((lambda *s: torch.randn(*s, dtype=torch.bfloat16) * 0.8)(D, F) * (D ** -0.5)),
            "w2": _w((lambda *s: torch.randn(*s, dtype=torch.bfloat16) * 0.1)(F, D) * (F ** -0.5)),
        }
    _B_in = _B_setup()

    return {
        "A_x": _A_in["x"],
        "A_wqkv": _A_in["wqkv"],
        "A_wo": _A_in["wo"],
        "B_x": _B_in["x"],
        "B_w1": _B_in["w1"],
        "B_w2": _B_in["w2"],
    }

def reference(A_x, A_wqkv, A_wo, B_x, B_w1, B_w2):
    def _A_ref(x, wqkv, wo):
        B, S, D = x.shape
        H = 32; Dh = D // H
        W, dil = 8, 2
        qkv = (lambda x, *d: x.permute(*d))((x @ wqkv).reshape(B, S, 3, H, Dh), 2, 0, 3, 1, 4)
        q, k, v = qkv[0], qkv[1], qkv[2]
        scale = Dh ** -0.5
        pos = torch.arange(S)
        off = torch.arange(W) * dil
        idx = pos[:, None] - off[None, :]
        mask = idx >= 0
        idx_c = torch.where(mask, idx, 0).reshape(-1)
        kg = k[:, :, idx_c, :].reshape(B, H, S, W, Dh)
        vg = v[:, :, idx_c, :].reshape(B, H, S, W, Dh)
        logits = torch.einsum("bhsd,bhswd->bhsw", q, kg) * scale
        logits = torch.where(mask[None, None, :, :], logits, -1e9)
        attn = _softmax(logits, axis=-1)
        o = torch.einsum("bhsw,bhswd->bhsd", attn, vg)
        return (lambda x, *d: x.permute(*d))(o, 0, 2, 1, 3).reshape(B, S, D) @ wo

    def _B_ref(x, w1, w2):
        h = torch.einsum("bsd,df->bsf", x, w1)
        h = _silu(h)
        out = torch.einsum("bsf,fd->bsd", h, w2)
        return out

    x = A_x
    xn = _layernorm(x, axis=-1)
    s = _A_ref(xn, A_wqkv, A_wo)
    g = _silu(_B_ref(xn, B_w1, B_w2))
    return x + s * g
```

```asm
; @launch grid=(256,1,1) block=(512,1,1) lds=159744
.amdgcn_target "amdgcn-amd-amdhsa--gfx950"
.text
.globl recurrent_scan__sliding_local_dilated__dense_activation_silu__prompt_kernel
.p2align 8
.type recurrent_scan__sliding_local_dilated__dense_activation_silu__prompt_kernel,@function
recurrent_scan__sliding_local_dilated__dense_activation_silu__prompt_kernel:
    s_cmp_ge_u32 s2, 256
    s_cbranch_scc1 fz_done
    s_load_dwordx4 s[4:7], s[0:1], 0
    s_load_dwordx2 s[8:9], s[0:1], 16
    s_load_dwordx2 s[12:13], s[0:1], 32
    s_load_dwordx2 s[32:33], s[0:1], 40
    s_load_dwordx2 s[80:81], s[0:1], 48
    s_load_dwordx2 s[34:35], s[0:1], 56
    s_load_dwordx2 s[10:11], s[0:1], 64
    v_lshrrev_b32 v1, 6, v0
    v_and_b32 v0, 63, v0
    v_readfirstlane_b32 s19, v1
    s_and_b32 s16, s2, 7
    s_lshr_b32 s17, s2, 3
    s_and_b32 s14, s16, 3
    s_lshl_b32 s14, s14, 1
    s_lshr_b32 s16, s16, 2
    s_cmp_ge_u32 s2, 152
    s_cbranch_scc1 fz_ffn
    s_mul_i32 s16, s16, 19
    s_add_u32 s16, s16, s17
    s_lshr_b32 s15, s16, 1
    s_and_b32 s16, s16, 1
    s_add_u32 s14, s14, s16
    s_cmp_ge_u32 s19, 4
    s_cbranch_scc1 fz_q_loader
    s_mov_b32 s3, s19
    s_or_b32 s22, s17, s19
    s_cmp_lg_u32 s22, 0
    s_cbranch_scc1 fz_q_pfskip
    s_getpc_b64 s[60:61]
pf_q:
    v_lshlrev_b32 v250, 7, v0
    v_add_u32 v251, 0, v250
    v_min_u32 v251, text_end-pf_q-4, v251
    global_load_dword v252, v251, s[60:61]
    v_add_u32 v251, 8192, v250
    v_min_u32 v251, text_end-pf_q-4, v251
    global_load_dword v252, v251, s[60:61]
    v_add_u32 v251, 16384, v250
    v_min_u32 v251, text_end-pf_q-4, v251
    global_load_dword v252, v251, s[60:61]
    v_add_u32 v251, 24576, v250
    v_min_u32 v251, text_end-pf_q-4, v251
    global_load_dword v252, v251, s[60:61]
fz_q_pfskip:
    s_or_b32 s22, s2, s19
    s_cmp_lg_u32 s22, 0
    s_cbranch_scc1 fz_nonce_publish
    s_memrealtime s[82:83]
    s_waitcnt lgkmcnt(0)
    s_or_b32 s82, s82, 1
    s_mov_b32 s84, s34
    s_mov_b32 s85, s35
    s_mov_b32 s86, 256
    s_mov_b32 s87, 0x00020000
    v_mov_b32 v3, 128
    v_mov_b32 v4, s82
    s_mov_b64 exec, 1
    buffer_store_dword v4, v3, s[84:87], 0 offen sc1
    s_mov_b64 exec, -1
fz_nonce_publish:
    s_and_b32 s20, s3, 1
    s_lshr_b32 s21, s3, 1
    v_and_b32 v3, 15, v0
    v_lshrrev_b32 v4, 4, v0
    v_and_b32 v5, 7, v3
    v_xor_b32 v5, v5, v4
    v_lshlrev_b32 v6, 7, v3
    v_lshl_add_u32 v6, v5, 4, v6
    s_mul_i32 s22, s20, 8192
    v_add_u32 v208, s22, v6
    v_xor_b32 v209, 64, v208
    v_lshrrev_b32 v5, 2, v0
    v_and_b32 v5, 3, v5
    v_and_b32 v6, 3, v0
    v_lshl_add_u32 v7, v4, 3, v5
    v_mul_u32_u24 v7, 512, v7
    v_and_b32 v3, 1, v6
    v_lshl_add_u32 v7, v3, 3, v7
    v_add_u32 v7, 16384, v7
    v_lshrrev_b32 v6, 1, v6
    v_and_b32 v3, 1, v4
    v_lshlrev_b32 v5, 1, v5
    v_lshl_or_b32 v5, v3, 3, v5
    v_or_b32 v6, v6, v5
    s_mul_i32 s22, s21, 8
    s_mul_i32 s23, s20, 0
    s_add_u32 s24, s23, 0
    s_cmp_ge_u32 s24, 8
    s_cselect_b32 s25, 8, 0
    s_sub_u32 s24, s24, s25
    s_add_u32 s24, s24, s22
    s_lshl_b32 s52, s24, 1
    v_xor_b32 v3, s52, v6
    v_lshl_add_u32 v200, v3, 4, v7
    s_add_u32 s24, s23, 1
    s_cmp_ge_u32 s24, 8
    s_cselect_b32 s25, 8, 0
    s_sub_u32 s24, s24, s25
    s_add_u32 s24, s24, s22
    s_lshl_b32 s53, s24, 1
    v_xor_b32 v3, s53, v6
    v_lshl_add_u32 v201, v3, 4, v7
    s_add_u32 s24, s23, 2
    s_cmp_ge_u32 s24, 8
    s_cselect_b32 s25, 8, 0
    s_sub_u32 s24, s24, s25
    s_add_u32 s24, s24, s22
    s_lshl_b32 s54, s24, 1
    v_xor_b32 v3, s54, v6
    v_lshl_add_u32 v202, v3, 4, v7
    s_add_u32 s24, s23, 3
    s_cmp_ge_u32 s24, 8
    s_cselect_b32 s25, 8, 0
    s_sub_u32 s24, s24, s25
    s_add_u32 s24, s24, s22
    s_lshl_b32 s55, s24, 1
    v_xor_b32 v3, s55, v6
    v_lshl_add_u32 v203, v3, 4, v7
    s_add_u32 s24, s23, 4
    s_cmp_ge_u32 s24, 8
    s_cselect_b32 s25, 8, 0
    s_sub_u32 s24, s24, s25
    s_add_u32 s24, s24, s22
    s_lshl_b32 s56, s24, 1
    v_xor_b32 v3, s56, v6
    v_lshl_add_u32 v204, v3, 4, v7
    s_add_u32 s24, s23, 5
    s_cmp_ge_u32 s24, 8
    s_cselect_b32 s25, 8, 0
    s_sub_u32 s24, s24, s25
    s_add_u32 s24, s24, s22
    s_lshl_b32 s57, s24, 1
    v_xor_b32 v3, s57, v6
    v_lshl_add_u32 v205, v3, 4, v7
    s_add_u32 s24, s23, 6
    s_cmp_ge_u32 s24, 8
    s_cselect_b32 s25, 8, 0
    s_sub_u32 s24, s24, s25
    s_add_u32 s24, s24, s22
    s_lshl_b32 s58, s24, 1
    v_xor_b32 v3, s58, v6
    v_lshl_add_u32 v206, v3, 4, v7
    s_add_u32 s24, s23, 7
    s_cmp_ge_u32 s24, 8
    s_cselect_b32 s25, 8, 0
    s_sub_u32 s24, s24, s25
    s_add_u32 s24, s24, s22
    s_lshl_b32 s59, s24, 1
    v_xor_b32 v3, s59, v6
    v_lshl_add_u32 v207, v3, 4, v7
    s_and_b32 s22, s19, 3
    s_lshr_b32 s23, s19, 2
    v_lshrrev_b32 v3, 2, v0
    v_and_b32 v4, 3, v0
    v_and_b32 v5, 1, v3
    v_lshrrev_b32 v6, 1, v3
    v_lshl_add_u32 v7, v6, 3, v5
    s_lshl_b32 s24, s23, 6
    v_add_u32 v7, s24, v7
    v_lshl_add_u32 v12, v4, 1, v7
    s_mul_i32 s25, s22, 40
    v_mul_u32_u24 v13, 488, v12
    v_add_u32 v13, s25, v13
    v_add_u32 v216, 7808, v13
    v_add_u32 v217, 160, v13
    v_mul_u32_u24 v13, 176, v12
    v_add_u32 v13, s25, v13
    v_add_u32 v219, 65536, v13
    v_lshrrev_b32 v13, 4, v0
    v_lshl_add_u32 v13, v13, 2, v4
    v_and_b32 v14, 1, v13
    v_lshrrev_b32 v13, 1, v13
    v_lshl_add_u32 v13, v13, 3, v14
    v_add_u32 v13, s24, v13
    v_and_b32 v14, 3, v3
    v_lshl_add_u32 v13, v14, 1, v13
    v_mul_u32_u24 v13, 488, v13
    v_add_u32 v13, s25, v13
    v_add_u32 v218, 320, v13
    s_mul_i32 s26, s15, 112
    v_add_u32 v12, s26, v7
    v_sub_u32 v12, 17, v12
    v_ashrrev_i32 v12, 1, v12
    v_add_u32 v13, 1, v4
    v_max_i32 v12, v12, v13
    v_add_u32 v13, 8, v4
    v_sub_u32 v13, v13, v12
    v_mov_b32 v14, 0xf149f2ca
    v_mov_b32 v15, 0
    v_sub_u32 v5, 1, v12
    v_cmp_le_u32 vcc, v5, v13
    s_nop 1
    v_cndmask_b32 v220, v14, v15, vcc
    v_sub_u32 v5, 2, v12
    v_cmp_le_u32 vcc, v5, v13
    s_nop 1
    v_cndmask_b32 v221, v14, v15, vcc
    v_sub_u32 v5, 3, v12
    v_cmp_le_u32 vcc, v5, v13
    s_nop 1
    v_cndmask_b32 v222, v14, v15, vcc
    v_sub_u32 v5, 4, v12
    v_cmp_le_u32 vcc, v5, v13
    s_nop 1
    v_cndmask_b32 v223, v14, v15, vcc
    v_sub_u32 v5, 5, v12
    v_cmp_le_u32 vcc, v5, v13
    s_nop 1
    v_cndmask_b32 v224, v14, v15, vcc
    v_sub_u32 v5, 6, v12
    v_cmp_le_u32 vcc, v5, v13
    s_nop 1
    v_cndmask_b32 v225, v14, v15, vcc
    v_sub_u32 v5, 7, v12
    v_cmp_le_u32 vcc, v5, v13
    s_nop 1
    v_cndmask_b32 v226, v14, v15, vcc
    v_sub_u32 v5, 8, v12
    v_cmp_le_u32 vcc, v5, v13
    s_nop 1
    v_cndmask_b32 v227, v14, v15, vcc
    v_sub_u32 v5, 9, v12
    v_cmp_le_u32 vcc, v5, v13
    s_nop 1
    v_cndmask_b32 v228, v14, v15, vcc
    v_sub_u32 v5, 10, v12
    v_cmp_le_u32 vcc, v5, v13
    s_nop 1
    v_cndmask_b32 v229, v14, v15, vcc
    v_sub_u32 v5, 11, v12
    v_cmp_le_u32 vcc, v5, v13
    s_nop 1
    v_cndmask_b32 v230, v14, v15, vcc
    v_lshrrev_b32 v3, 4, v0
    v_and_b32 v4, 15, v0
    s_mul_i32 s26, s15, 7
    s_mul_i32 s27, s14, 10
    s_lshl_b32 s25, s19, 2
    s_add_u32 s25, s25, 0
    v_add_u32 v5, s25, v3
    v_mul_u32_u24 v6, 205, v5
    v_lshrrev_b32 v6, 11, v6
    v_mul_u32_u24 v7, 10, v6
    v_sub_u32 v7, v5, v7
    v_lshl_add_u32 v12, v6, 4, v4
    v_mul_u32_u24 v12, 176, v12
    v_lshl_add_u32 v12, v7, 4, v12
    v_add_u32 v232, 65536, v12
    v_add_u32 v7, s27, v7
    v_add_u32 v12, s26, v6
    v_mul_u32_u24 v12, 68, v12
    v_lshrrev_b32 v13, 2, v7
    v_add_u32 v12, v12, v13
    v_lshlrev_b32 v12, 10, v12
    v_and_b32 v13, 3, v7
    v_lshl_add_u32 v13, v13, 4, v4
    v_lshl_add_u32 v12, v13, 4, v12
    v_cmp_gt_u32 vcc, 70, v5
    v_mov_b32 v13, 0x80000000
    s_nop 0
    v_cndmask_b32 v236, v13, v12, vcc
    s_lshl_b32 s25, s19, 2
    s_add_u32 s25, s25, 32
    v_add_u32 v5, s25, v3
    v_mul_u32_u24 v6, 205, v5
    v_lshrrev_b32 v6, 11, v6
    v_mul_u32_u24 v7, 10, v6
    v_sub_u32 v7, v5, v7
    v_lshl_add_u32 v12, v6, 4, v4
    v_mul_u32_u24 v12, 176, v12
    v_lshl_add_u32 v12, v7, 4, v12
    v_add_u32 v233, 65536, v12
    v_add_u32 v7, s27, v7
    v_add_u32 v12, s26, v6
    v_mul_u32_u24 v12, 68, v12
    v_lshrrev_b32 v13, 2, v7
    v_add_u32 v12, v12, v13
    v_lshlrev_b32 v12, 10, v12
    v_and_b32 v13, 3, v7
    v_lshl_add_u32 v13, v13, 4, v4
    v_lshl_add_u32 v12, v13, 4, v12
    v_cmp_gt_u32 vcc, 70, v5
    v_mov_b32 v13, 0x80000000
    s_nop 0
    v_cndmask_b32 v237, v13, v12, vcc
    s_lshl_b32 s25, s19, 2
    s_add_u32 s25, s25, 64
    v_add_u32 v5, s25, v3
    v_mul_u32_u24 v6, 205, v5
    v_lshrrev_b32 v6, 11, v6
    v_mul_u32_u24 v7, 10, v6
    v_sub_u32 v7, v5, v7
    v_lshl_add_u32 v12, v6, 4, v4
    v_mul_u32_u24 v12, 176, v12
    v_lshl_add_u32 v12, v7, 4, v12
    v_add_u32 v234, 65536, v12
    v_add_u32 v7, s27, v7
    v_add_u32 v12, s26, v6
    v_mul_u32_u24 v12, 68, v12
    v_lshrrev_b32 v13, 2, v7
    v_add_u32 v12, v12, v13
    v_lshlrev_b32 v12, 10, v12
    v_and_b32 v13, 3, v7
    v_lshl_add_u32 v13, v13, 4, v4
    v_lshl_add_u32 v12, v13, 4, v12
    v_cmp_gt_u32 vcc, 70, v5
    v_mov_b32 v13, 0x80000000
    s_nop 0
    v_cndmask_b32 v238, v13, v12, vcc
    v_mov_b32 v8, 0
    v_mov_b32 v9, 0
    v_mov_b32 v10, 0
    v_mov_b32 v11, 0
    v_mov_b32 v12, 0
    v_mov_b32 v13, 0
    v_mov_b32 v14, 0
    v_mov_b32 v15, 0
    v_mov_b32 v16, 0
    v_mov_b32 v17, 0
    v_mov_b32 v18, 0
    v_mov_b32 v19, 0
    v_mov_b32 v20, 0
    v_mov_b32 v21, 0
    v_mov_b32 v22, 0
    v_mov_b32 v23, 0
    v_mov_b32 v24, 0
    v_mov_b32 v25, 0
    v_mov_b32 v26, 0
    v_mov_b32 v27, 0
    v_mov_b32 v28, 0
    v_mov_b32 v29, 0
    v_mov_b32 v30, 0
    v_mov_b32 v31, 0
    v_mov_b32 v32, 0
    v_mov_b32 v33, 0
    v_mov_b32 v34, 0
    v_mov_b32 v35, 0
    v_mov_b32 v36, 0
    v_mov_b32 v37, 0
    v_mov_b32 v38, 0
    v_mov_b32 v39, 0
    v_mov_b32 v40, 0
    v_mov_b32 v41, 0
    v_mov_b32 v42, 0
    v_mov_b32 v43, 0
    v_mov_b32 v44, 0
    v_mov_b32 v45, 0
    v_mov_b32 v46, 0
    v_mov_b32 v47, 0
    v_mov_b32 v48, 0
    v_mov_b32 v49, 0
    v_mov_b32 v50, 0
    v_mov_b32 v51, 0
    v_mov_b32 v52, 0
    v_mov_b32 v53, 0
    v_mov_b32 v54, 0
    v_mov_b32 v55, 0
    v_mov_b32 v56, 0
    v_mov_b32 v57, 0
    v_mov_b32 v58, 0
    v_mov_b32 v59, 0
    v_mov_b32 v60, 0
    v_mov_b32 v61, 0
    v_mov_b32 v62, 0
    v_mov_b32 v63, 0
    v_mov_b32 v64, 0
    v_mov_b32 v65, 0
    v_mov_b32 v66, 0
    v_mov_b32 v67, 0
    v_mov_b32 v68, 0
    v_mov_b32 v69, 0
    v_mov_b32 v70, 0
    v_mov_b32 v71, 0
    v_mov_b32 v72, 0
    v_mov_b32 v73, 0
    v_mov_b32 v74, 0
    v_mov_b32 v75, 0
    v_mov_b32 v76, 0
    v_mov_b32 v77, 0
    v_mov_b32 v78, 0
    v_mov_b32 v79, 0
    v_mov_b32 v80, 0
    v_mov_b32 v81, 0
    v_mov_b32 v82, 0
    v_mov_b32 v83, 0
    v_mov_b32 v84, 0
    v_mov_b32 v85, 0
    v_mov_b32 v86, 0
    v_mov_b32 v87, 0
    v_mov_b32 v88, 0
    v_mov_b32 v89, 0
    v_mov_b32 v90, 0
    v_mov_b32 v91, 0
    v_mov_b32 v92, 0
    v_mov_b32 v93, 0
    v_mov_b32 v94, 0
    v_mov_b32 v95, 0
    v_mov_b32 v96, 0
    v_mov_b32 v97, 0
    v_mov_b32 v98, 0
    v_mov_b32 v99, 0
    v_mov_b32 v100, 0
    v_mov_b32 v101, 0
    v_mov_b32 v102, 0
    v_mov_b32 v103, 0
    v_mov_b32 v104, 0
    v_mov_b32 v105, 0
    v_mov_b32 v106, 0
    v_mov_b32 v107, 0
    v_mov_b32 v108, 0
    v_mov_b32 v109, 0
    v_mov_b32 v110, 0
    v_mov_b32 v111, 0
    v_mov_b32 v112, 0
    v_mov_b32 v113, 0
    v_mov_b32 v114, 0
    v_mov_b32 v115, 0
    v_mov_b32 v116, 0
    v_mov_b32 v117, 0
    v_mov_b32 v118, 0
    v_mov_b32 v119, 0
    v_mov_b32 v120, 0
    v_mov_b32 v121, 0
    v_mov_b32 v122, 0
    v_mov_b32 v123, 0
    v_mov_b32 v124, 0
    v_mov_b32 v125, 0
    v_mov_b32 v126, 0
    v_mov_b32 v127, 0
    v_mov_b32 v128, 0
    v_mov_b32 v129, 0
    v_mov_b32 v130, 0
    v_mov_b32 v131, 0
    v_mov_b32 v132, 0
    v_mov_b32 v133, 0
    v_mov_b32 v134, 0
    v_mov_b32 v135, 0
    s_cmp_lg_u32 s3, 0
    s_cbranch_scc1 fz_ones_done
    v_mov_b32 v168, 0x3f803f80
    v_mov_b32 v169, 0x3f803f80
    v_mov_b32 v170, 0x3f803f80
    v_mov_b32 v171, 0x3f803f80
    v_lshlrev_b32 v3, 4, v0
    s_mov_b64 exec, 0xff
    ds_write_b128 v3, v[168:171]
    ds_write_b128 v3, v[168:171] offset:49152
    v_add_u32 v3, 98304, v3
    ds_write_b128 v3, v[168:171]
    s_mov_b64 exec, -1
fz_ones_done:
    s_waitcnt lgkmcnt(0)
    s_mov_b32 s17, 0
    s_barrier
    ds_read_b128 v[168:171], v208 offset:0
    ds_read_b128 v[172:175], v208 offset:2048
    ds_read_b128 v[176:179], v208 offset:4096
    ds_read_b128 v[180:183], v208 offset:6144
    ds_read_b64_tr_b16 v[136:137], v200 offset:0
    ds_read_b64_tr_b16 v[138:139], v200 offset:2048
    ds_read_b64_tr_b16 v[140:141], v201 offset:0
    ds_read_b64_tr_b16 v[142:143], v201 offset:2048
    ds_read_b64_tr_b16 v[144:145], v202 offset:0
    ds_read_b64_tr_b16 v[146:147], v202 offset:2048
    ds_read_b64_tr_b16 v[148:149], v203 offset:0
    ds_read_b64_tr_b16 v[150:151], v203 offset:2048
    s_waitcnt lgkmcnt(4)
    ds_read_b64_tr_b16 v[152:153], v204 offset:0
    ds_read_b64_tr_b16 v[154:155], v204 offset:2048
    ds_read_b64_tr_b16 v[156:157], v205 offset:0
    ds_read_b64_tr_b16 v[158:159], v205 offset:2048
    ds_read_b64_tr_b16 v[160:161], v206 offset:0
    ds_read_b64_tr_b16 v[162:163], v206 offset:2048
    s_waitcnt lgkmcnt(0)
    s_mov_b32 s18, 10
fz_q_cloop:
    s_waitcnt lgkmcnt(12)
    v_mfma_f32_16x16x32_bf16 v[8:11], v[136:139], v[168:171], v[8:11]
    v_mfma_f32_16x16x32_bf16 v[12:15], v[136:139], v[172:175], v[12:15]
    ds_read_b64_tr_b16 v[164:165], v207 offset:0
    v_mfma_f32_16x16x32_bf16 v[16:19], v[136:139], v[176:179], v[16:19]
    ds_read_b64_tr_b16 v[166:167], v207 offset:2048
    v_mfma_f32_16x16x32_bf16 v[20:23], v[136:139], v[180:183], v[20:23]
    s_waitcnt lgkmcnt(10)
    ds_read_b128 v[184:187], v209 offset:0
    v_mfma_f32_16x16x32_bf16 v[24:27], v[140:143], v[168:171], v[24:27]
    v_mfma_f32_16x16x32_bf16 v[28:31], v[140:143], v[172:175], v[28:31]
    ds_read_b64_tr_b16 v[136:137], v200 offset:16384
    v_mfma_f32_16x16x32_bf16 v[32:35], v[140:143], v[176:179], v[32:35]
    ds_read_b64_tr_b16 v[138:139], v200 offset:18432
    v_mfma_f32_16x16x32_bf16 v[36:39], v[140:143], v[180:183], v[36:39]
    ds_read_b128 v[188:191], v209 offset:2048
    v_mfma_f32_16x16x32_bf16 v[40:43], v[144:147], v[168:171], v[40:43]
    v_mfma_f32_16x16x32_bf16 v[44:47], v[144:147], v[172:175], v[44:47]
    s_waitcnt lgkmcnt(10)
    ds_read_b64_tr_b16 v[140:141], v201 offset:16384
    v_mfma_f32_16x16x32_bf16 v[48:51], v[144:147], v[176:179], v[48:51]
    ds_read_b64_tr_b16 v[142:143], v201 offset:18432
    v_mfma_f32_16x16x32_bf16 v[52:55], v[144:147], v[180:183], v[52:55]
    ds_read_b128 v[192:195], v209 offset:4096
    v_mfma_f32_16x16x32_bf16 v[56:59], v[148:151], v[168:171], v[56:59]
    v_mfma_f32_16x16x32_bf16 v[60:63], v[148:151], v[172:175], v[60:63]
    ds_read_b64_tr_b16 v[144:145], v202 offset:16384
    v_mfma_f32_16x16x32_bf16 v[64:67], v[148:151], v[176:179], v[64:67]
    s_waitcnt lgkmcnt(10)
    ds_read_b64_tr_b16 v[146:147], v202 offset:18432
    v_mfma_f32_16x16x32_bf16 v[68:71], v[148:151], v[180:183], v[68:71]
    ds_read_b128 v[196:199], v209 offset:6144
    v_mfma_f32_16x16x32_bf16 v[72:75], v[152:155], v[168:171], v[72:75]
    v_mfma_f32_16x16x32_bf16 v[76:79], v[152:155], v[172:175], v[76:79]
    ds_read_b64_tr_b16 v[148:149], v203 offset:16384
    v_mfma_f32_16x16x32_bf16 v[80:83], v[152:155], v[176:179], v[80:83]
    v_mfma_f32_16x16x32_bf16 v[84:87], v[152:155], v[180:183], v[84:87]
    ds_read_b64_tr_b16 v[150:151], v203 offset:18432
    v_mfma_f32_16x16x32_bf16 v[88:91], v[156:159], v[168:171], v[88:91]
    v_mfma_f32_16x16x32_bf16 v[92:95], v[156:159], v[172:175], v[92:95]
    s_waitcnt lgkmcnt(10)
    ds_read_b64_tr_b16 v[152:153], v204 offset:16384
    v_mfma_f32_16x16x32_bf16 v[96:99], v[156:159], v[176:179], v[96:99]
    v_mfma_f32_16x16x32_bf16 v[100:103], v[156:159], v[180:183], v[100:103]
    ds_read_b64_tr_b16 v[154:155], v204 offset:18432
    v_mfma_f32_16x16x32_bf16 v[104:107], v[160:163], v[168:171], v[104:107]
    v_mfma_f32_16x16x32_bf16 v[108:111], v[160:163], v[172:175], v[108:111]
    ds_read_b64_tr_b16 v[156:157], v205 offset:16384
    v_mfma_f32_16x16x32_bf16 v[112:115], v[160:163], v[176:179], v[112:115]
    v_mfma_f32_16x16x32_bf16 v[116:119], v[160:163], v[180:183], v[116:119]
    ds_read_b64_tr_b16 v[158:159], v205 offset:18432
    v_mfma_f32_16x16x32_bf16 v[120:123], v[164:167], v[168:171], v[120:123]
    v_mfma_f32_16x16x32_bf16 v[124:127], v[164:167], v[172:175], v[124:127]
    s_waitcnt lgkmcnt(10)
    ds_read_b64_tr_b16 v[160:161], v206 offset:16384
    v_mfma_f32_16x16x32_bf16 v[128:131], v[164:167], v[176:179], v[128:131]
    v_mfma_f32_16x16x32_bf16 v[132:135], v[164:167], v[180:183], v[132:135]
    ds_read_b64_tr_b16 v[162:163], v206 offset:18432
    s_waitcnt lgkmcnt(8)
    v_mfma_f32_16x16x32_bf16 v[8:11], v[136:139], v[184:187], v[8:11]
    ds_read_b64_tr_b16 v[164:165], v207 offset:16384
    v_mfma_f32_16x16x32_bf16 v[12:15], v[136:139], v[188:191], v[12:15]
    ds_read_b64_tr_b16 v[166:167], v207 offset:18432
    s_add_u32 s17, s17, 49152
    v_mfma_f32_16x16x32_bf16 v[16:19], v[136:139], v[192:195], v[16:19]
    s_cmp_eq_u32 s17, 147456
    v_mfma_f32_16x16x32_bf16 v[20:23], v[136:139], v[196:199], v[20:23]
    s_cselect_b32 s22, 147456, 0
    s_sub_u32 s23, 49152, s22
    v_mfma_f32_16x16x32_bf16 v[24:27], v[140:143], v[184:187], v[24:27]
    s_sub_u32 s17, s17, s22
    v_mfma_f32_16x16x32_bf16 v[28:31], v[140:143], v[188:191], v[28:31]
    v_add_u32 v200, s23, v200
    v_add_u32 v201, s23, v201
    v_mfma_f32_16x16x32_bf16 v[32:35], v[140:143], v[192:195], v[32:35]
    v_add_u32 v202, s23, v202
    v_mfma_f32_16x16x32_bf16 v[36:39], v[140:143], v[196:199], v[36:39]
    v_add_u32 v203, s23, v203
    v_add_u32 v204, s23, v204
    v_mfma_f32_16x16x32_bf16 v[40:43], v[144:147], v[184:187], v[40:43]
    v_add_u32 v205, s23, v205
    v_mfma_f32_16x16x32_bf16 v[44:47], v[144:147], v[188:191], v[44:47]
    v_add_u32 v206, s23, v206
    v_mfma_f32_16x16x32_bf16 v[48:51], v[144:147], v[192:195], v[48:51]
    v_add_u32 v208, s23, v208
    v_mfma_f32_16x16x32_bf16 v[52:55], v[144:147], v[196:199], v[52:55]
    v_add_u32 v209, s23, v209
    v_add_u32 v207, s23, v207
    s_waitcnt lgkmcnt(0)
    s_barrier
    v_mfma_f32_16x16x32_bf16 v[56:59], v[148:151], v[184:187], v[56:59]
    ds_read_b128 v[168:171], v208 offset:0
    v_mfma_f32_16x16x32_bf16 v[60:63], v[148:151], v[188:191], v[60:63]
    ds_read_b128 v[172:175], v208 offset:2048
    v_mfma_f32_16x16x32_bf16 v[64:67], v[148:151], v[192:195], v[64:67]
    ds_read_b128 v[176:179], v208 offset:4096
    v_mfma_f32_16x16x32_bf16 v[68:71], v[148:151], v[196:199], v[68:71]
    ds_read_b128 v[180:183], v208 offset:6144
    ds_read_b64_tr_b16 v[136:137], v200 offset:0
    v_mfma_f32_16x16x32_bf16 v[72:75], v[152:155], v[184:187], v[72:75]
    ds_read_b64_tr_b16 v[138:139], v200 offset:2048
    v_mfma_f32_16x16x32_bf16 v[76:79], v[152:155], v[188:191], v[76:79]
    ds_read_b64_tr_b16 v[140:141], v201 offset:0
    v_mfma_f32_16x16x32_bf16 v[80:83], v[152:155], v[192:195], v[80:83]
    ds_read_b64_tr_b16 v[142:143], v201 offset:2048
    v_mfma_f32_16x16x32_bf16 v[84:87], v[152:155], v[196:199], v[84:87]
    ds_read_b64_tr_b16 v[144:145], v202 offset:0
    ds_read_b64_tr_b16 v[146:147], v202 offset:2048
    v_mfma_f32_16x16x32_bf16 v[88:91], v[156:159], v[184:187], v[88:91]
    ds_read_b64_tr_b16 v[148:149], v203 offset:0
    v_mfma_f32_16x16x32_bf16 v[92:95], v[156:159], v[188:191], v[92:95]
    ds_read_b64_tr_b16 v[150:151], v203 offset:2048
    v_mfma_f32_16x16x32_bf16 v[96:99], v[156:159], v[192:195], v[96:99]
    ds_read_b64_tr_b16 v[152:153], v204 offset:0
    v_mfma_f32_16x16x32_bf16 v[100:103], v[156:159], v[196:199], v[100:103]
    ds_read_b64_tr_b16 v[154:155], v204 offset:2048
    v_mfma_f32_16x16x32_bf16 v[104:107], v[160:163], v[184:187], v[104:107]
    v_mfma_f32_16x16x32_bf16 v[108:111], v[160:163], v[188:191], v[108:111]
    s_waitcnt lgkmcnt(10)
    ds_read_b64_tr_b16 v[156:157], v205 offset:0
    v_mfma_f32_16x16x32_bf16 v[112:115], v[160:163], v[192:195], v[112:115]
    v_mfma_f32_16x16x32_bf16 v[116:119], v[160:163], v[196:199], v[116:119]
    ds_read_b64_tr_b16 v[158:159], v205 offset:2048
    v_mfma_f32_16x16x32_bf16 v[120:123], v[164:167], v[184:187], v[120:123]
    v_mfma_f32_16x16x32_bf16 v[124:127], v[164:167], v[188:191], v[124:127]
    ds_read_b64_tr_b16 v[160:161], v206 offset:0
    v_mfma_f32_16x16x32_bf16 v[128:131], v[164:167], v[192:195], v[128:131]
    v_mfma_f32_16x16x32_bf16 v[132:135], v[164:167], v[196:199], v[132:135]
    ds_read_b64_tr_b16 v[162:163], v206 offset:2048
    s_sub_u32 s18, s18, 1
    s_cmp_lg_u32 s18, 0
    s_cbranch_scc1 fz_q_cloop
    s_waitcnt lgkmcnt(0)
    v_and_b32 v3, 15, v0
    v_lshlrev_b32 v3, 3, v3
    s_mul_i32 s22, s20, 512
    s_add_u32 s22, s22, 147456
    v_add_u32 v3, s22, v3
    ds_read_b64 v[168:169], v3 offset:0
    ds_read_b64 v[170:171], v3 offset:128
    ds_read_b64 v[172:173], v3 offset:256
    ds_read_b64 v[174:175], v3 offset:384
    v_lshrrev_b32 v4, 4, v0
    v_lshlrev_b32 v5, 4, v4
    v_add_u32 v5, 148480, v5
    s_lshl_b32 s22, s52, 5
    v_add_u32 v200, s22, v5
    s_lshl_b32 s22, s53, 5
    v_add_u32 v201, s22, v5
    s_lshl_b32 s22, s54, 5
    v_add_u32 v202, s22, v5
    s_lshl_b32 s22, s55, 5
    v_add_u32 v203, s22, v5
    s_lshl_b32 s22, s56, 5
    v_add_u32 v204, s22, v5
    s_lshl_b32 s22, s57, 5
    v_add_u32 v205, s22, v5
    s_lshl_b32 s22, s58, 5
    v_add_u32 v206, s22, v5
    s_lshl_b32 s22, s59, 5
    v_add_u32 v207, s22, v5
    s_mov_b32 s50, 0x00010001
    s_mov_b32 s51, 0x00010001
    s_cmp_eq_u32 s20, 0
    s_cbranch_scc0 cs_skip_1
    s_mov_b64 exec, s[50:51]
    ds_write_b128 v200, v[8:11]
    ds_write_b128 v201, v[24:27]
    ds_write_b128 v202, v[40:43]
    ds_write_b128 v203, v[56:59]
    ds_write_b128 v204, v[72:75]
    ds_write_b128 v205, v[88:91]
    ds_write_b128 v206, v[104:107]
    ds_write_b128 v207, v[120:123]
    s_mov_b64 exec, -1
cs_skip_1:
    s_waitcnt lgkmcnt(8)
    s_cmp_eq_u32 s20, 0
    s_cbranch_scc1 cs_w_2
    s_waitcnt lgkmcnt(0)
cs_w_2:
    v_pk_mul_f32 v[8:9], v[8:9], v[168:169] op_sel:[0,1] op_sel_hi:[1,1]
    v_pk_mul_f32 v[10:11], v[10:11], v[168:169] op_sel:[0,1] op_sel_hi:[1,1]
    v_pk_mul_f32 v[12:13], v[12:13], v[170:171] op_sel:[0,1] op_sel_hi:[1,1]
    v_pk_mul_f32 v[14:15], v[14:15], v[170:171] op_sel:[0,1] op_sel_hi:[1,1]
    v_pk_mul_f32 v[16:17], v[16:17], v[172:173] op_sel:[0,1] op_sel_hi:[1,1]
    v_pk_mul_f32 v[18:19], v[18:19], v[172:173] op_sel:[0,1] op_sel_hi:[1,1]
    v_pk_mul_f32 v[20:21], v[20:21], v[174:175] op_sel:[0,1] op_sel_hi:[1,1]
    v_pk_mul_f32 v[22:23], v[22:23], v[174:175] op_sel:[0,1] op_sel_hi:[1,1]
    v_pk_mul_f32 v[24:25], v[24:25], v[168:169] op_sel:[0,1] op_sel_hi:[1,1]
    v_pk_mul_f32 v[26:27], v[26:27], v[168:169] op_sel:[0,1] op_sel_hi:[1,1]
    v_pk_mul_f32 v[28:29], v[28:29], v[170:171] op_sel:[0,1] op_sel_hi:[1,1]
    v_pk_mul_f32 v[30:31], v[30:31], v[170:171] op_sel:[0,1] op_sel_hi:[1,1]
    v_pk_mul_f32 v[32:33], v[32:33], v[172:173] op_sel:[0,1] op_sel_hi:[1,1]
    v_pk_mul_f32 v[34:35], v[34:35], v[172:173] op_sel:[0,1] op_sel_hi:[1,1]
    v_pk_mul_f32 v[36:37], v[36:37], v[174:175] op_sel:[0,1] op_sel_hi:[1,1]
    v_pk_mul_f32 v[38:39], v[38:39], v[174:175] op_sel:[0,1] op_sel_hi:[1,1]
    v_pk_mul_f32 v[40:41], v[40:41], v[168:169] op_sel:[0,1] op_sel_hi:[1,1]
    v_pk_mul_f32 v[42:43], v[42:43], v[168:169] op_sel:[0,1] op_sel_hi:[1,1]
    v_pk_mul_f32 v[44:45], v[44:45], v[170:171] op_sel:[0,1] op_sel_hi:[1,1]
    v_pk_mul_f32 v[46:47], v[46:47], v[170:171] op_sel:[0,1] op_sel_hi:[1,1]
    v_pk_mul_f32 v[48:49], v[48:49], v[172:173] op_sel:[0,1] op_sel_hi:[1,1]
    v_pk_mul_f32 v[50:51], v[50:51], v[172:173] op_sel:[0,1] op_sel_hi:[1,1]
    v_pk_mul_f32 v[52:53], v[52:53], v[174:175] op_sel:[0,1] op_sel_hi:[1,1]
    v_pk_mul_f32 v[54:55], v[54:55], v[174:175] op_sel:[0,1] op_sel_hi:[1,1]
    v_pk_mul_f32 v[56:57], v[56:57], v[168:169] op_sel:[0,1] op_sel_hi:[1,1]
    v_pk_mul_f32 v[58:59], v[58:59], v[168:169] op_sel:[0,1] op_sel_hi:[1,1]
    v_pk_mul_f32 v[60:61], v[60:61], v[170:171] op_sel:[0,1] op_sel_hi:[1,1]
    v_pk_mul_f32 v[62:63], v[62:63], v[170:171] op_sel:[0,1] op_sel_hi:[1,1]
    v_pk_mul_f32 v[64:65], v[64:65], v[172:173] op_sel:[0,1] op_sel_hi:[1,1]
    v_pk_mul_f32 v[66:67], v[66:67], v[172:173] op_sel:[0,1] op_sel_hi:[1,1]
    v_pk_mul_f32 v[68:69], v[68:69], v[174:175] op_sel:[0,1] op_sel_hi:[1,1]
    v_pk_mul_f32 v[70:71], v[70:71], v[174:175] op_sel:[0,1] op_sel_hi:[1,1]
    v_pk_mul_f32 v[72:73], v[72:73], v[168:169] op_sel:[0,1] op_sel_hi:[1,1]
    v_pk_mul_f32 v[74:75], v[74:75], v[168:169] op_sel:[0,1] op_sel_hi:[1,1]
    v_pk_mul_f32 v[76:77], v[76:77], v[170:171] op_sel:[0,1] op_sel_hi:[1,1]
    v_pk_mul_f32 v[78:79], v[78:79], v[170:171] op_sel:[0,1] op_sel_hi:[1,1]
    v_pk_mul_f32 v[80:81], v[80:81], v[172:173] op_sel:[0,1] op_sel_hi:[1,1]
    v_pk_mul_f32 v[82:83], v[82:83], v[172:173] op_sel:[0,1] op_sel_hi:[1,1]
    v_pk_mul_f32 v[84:85], v[84:85], v[174:175] op_sel:[0,1] op_sel_hi:[1,1]
    v_pk_mul_f32 v[86:87], v[86:87], v[174:175] op_sel:[0,1] op_sel_hi:[1,1]
    v_pk_mul_f32 v[88:89], v[88:89], v[168:169] op_sel:[0,1] op_sel_hi:[1,1]
    v_pk_mul_f32 v[90:91], v[90:91], v[168:169] op_sel:[0,1] op_sel_hi:[1,1]
    v_pk_mul_f32 v[92:93], v[92:93], v[170:171] op_sel:[0,1] op_sel_hi:[1,1]
    v_pk_mul_f32 v[94:95], v[94:95], v[170:171] op_sel:[0,1] op_sel_hi:[1,1]
    v_pk_mul_f32 v[96:97], v[96:97], v[172:173] op_sel:[0,1] op_sel_hi:[1,1]
    v_pk_mul_f32 v[98:99], v[98:99], v[172:173] op_sel:[0,1] op_sel_hi:[1,1]
    v_pk_mul_f32 v[100:101], v[100:101], v[174:175] op_sel:[0,1] op_sel_hi:[1,1]
    v_pk_mul_f32 v[102:103], v[102:103], v[174:175] op_sel:[0,1] op_sel_hi:[1,1]
    v_pk_mul_f32 v[104:105], v[104:105], v[168:169] op_sel:[0,1] op_sel_hi:[1,1]
    v_pk_mul_f32 v[106:107], v[106:107], v[168:169] op_sel:[0,1] op_sel_hi:[1,1]
    v_pk_mul_f32 v[108:109], v[108:109], v[170:171] op_sel:[0,1] op_sel_hi:[1,1]
    v_pk_mul_f32 v[110:111], v[110:111], v[170:171] op_sel:[0,1] op_sel_hi:[1,1]
    v_pk_mul_f32 v[112:113], v[112:113], v[172:173] op_sel:[0,1] op_sel_hi:[1,1]
    v_pk_mul_f32 v[114:115], v[114:115], v[172:173] op_sel:[0,1] op_sel_hi:[1,1]
    v_pk_mul_f32 v[116:117], v[116:117], v[174:175] op_sel:[0,1] op_sel_hi:[1,1]
    v_pk_mul_f32 v[118:119], v[118:119], v[174:175] op_sel:[0,1] op_sel_hi:[1,1]
    v_pk_mul_f32 v[120:121], v[120:121], v[168:169] op_sel:[0,1] op_sel_hi:[1,1]
    v_pk_mul_f32 v[122:123], v[122:123], v[168:169] op_sel:[0,1] op_sel_hi:[1,1]
    v_pk_mul_f32 v[124:125], v[124:125], v[170:171] op_sel:[0,1] op_sel_hi:[1,1]
    v_pk_mul_f32 v[126:127], v[126:127], v[170:171] op_sel:[0,1] op_sel_hi:[1,1]
    v_pk_mul_f32 v[128:129], v[128:129], v[172:173] op_sel:[0,1] op_sel_hi:[1,1]
    v_pk_mul_f32 v[130:131], v[130:131], v[172:173] op_sel:[0,1] op_sel_hi:[1,1]
    v_pk_mul_f32 v[132:133], v[132:133], v[174:175] op_sel:[0,1] op_sel_hi:[1,1]
    v_pk_mul_f32 v[134:135], v[134:135], v[174:175] op_sel:[0,1] op_sel_hi:[1,1]
    s_waitcnt lgkmcnt(0)
    s_barrier
    ds_read_b128 v[136:139], v200
    ds_read_b128 v[140:143], v201
    ds_read_b128 v[144:147], v202
    ds_read_b128 v[148:151], v203
    ds_read_b128 v[152:155], v204
    ds_read_b128 v[156:159], v205
    ds_read_b128 v[160:163], v206
    ds_read_b128 v[164:167], v207
    v_and_b32 v3, 15, v0
    s_lshl_b32 s22, s20, 6
    v_add_u32 v3, s22, v3
    v_mul_u32_u24 v3, 488, v3
    v_lshrrev_b32 v4, 4, v0
    v_lshl_add_u32 v3, v4, 3, v3
    s_lshl_b32 s22, s52, 4
    s_cmp_eq_u32 s52, 30
    s_cselect_b32 s22, 85248, s22
    v_add_u32 v6, s22, v3
    s_waitcnt lgkmcnt(0)
    v_pk_fma_f32 v[8:9], v[136:137], v[168:169], v[8:9] op_sel:[0,0,0] op_sel_hi:[1,0,1]
    v_pk_fma_f32 v[10:11], v[138:139], v[168:169], v[10:11] op_sel:[0,0,0] op_sel_hi:[1,0,1]
    v_cvt_pk_bf16_f32 v176, v8, v9
    v_cvt_pk_bf16_f32 v177, v10, v11
    v_pk_fma_f32 v[12:13], v[136:137], v[170:171], v[12:13] op_sel:[0,0,0] op_sel_hi:[1,0,1]
    v_pk_fma_f32 v[14:15], v[138:139], v[170:171], v[14:15] op_sel:[0,0,0] op_sel_hi:[1,0,1]
    ds_write_b64 v6, v[176:177] offset:0
    v_cvt_pk_bf16_f32 v178, v12, v13
    v_cvt_pk_bf16_f32 v179, v14, v15
    v_pk_fma_f32 v[16:17], v[136:137], v[172:173], v[16:17] op_sel:[0,0,0] op_sel_hi:[1,0,1]
    v_pk_fma_f32 v[18:19], v[138:139], v[172:173], v[18:19] op_sel:[0,0,0] op_sel_hi:[1,0,1]
    ds_write_b64 v6, v[178:179] offset:7808
    v_cvt_pk_bf16_f32 v180, v16, v17
    v_cvt_pk_bf16_f32 v181, v18, v19
    v_pk_fma_f32 v[20:21], v[136:137], v[174:175], v[20:21] op_sel:[0,0,0] op_sel_hi:[1,0,1]
    v_pk_fma_f32 v[22:23], v[138:139], v[174:175], v[22:23] op_sel:[0,0,0] op_sel_hi:[1,0,1]
    ds_write_b64 v6, v[180:181] offset:15616
    v_cvt_pk_bf16_f32 v182, v20, v21
    v_cvt_pk_bf16_f32 v183, v22, v23
    s_lshl_b32 s22, s53, 4
    s_cmp_eq_u32 s53, 30
    s_cselect_b32 s22, 85248, s22
    v_add_u32 v7, s22, v3
    v_pk_fma_f32 v[24:25], v[140:141], v[168:169], v[24:25] op_sel:[0,0,0] op_sel_hi:[1,0,1]
    v_pk_fma_f32 v[26:27], v[142:143], v[168:169], v[26:27] op_sel:[0,0,0] op_sel_hi:[1,0,1]
    ds_write_b64 v6, v[182:183] offset:23424
    v_cvt_pk_bf16_f32 v176, v24, v25
    v_cvt_pk_bf16_f32 v177, v26, v27
    v_pk_fma_f32 v[28:29], v[140:141], v[170:171], v[28:29] op_sel:[0,0,0] op_sel_hi:[1,0,1]
    v_pk_fma_f32 v[30:31], v[142:143], v[170:171], v[30:31] op_sel:[0,0,0] op_sel_hi:[1,0,1]
    ds_write_b64 v7, v[176:177] offset:0
    v_cvt_pk_bf16_f32 v178, v28, v29
    v_cvt_pk_bf16_f32 v179, v30, v31
    v_pk_fma_f32 v[32:33], v[140:141], v[172:173], v[32:33] op_sel:[0,0,0] op_sel_hi:[1,0,1]
    v_pk_fma_f32 v[34:35], v[142:143], v[172:173], v[34:35] op_sel:[0,0,0] op_sel_hi:[1,0,1]
    ds_write_b64 v7, v[178:179] offset:7808
    v_cvt_pk_bf16_f32 v180, v32, v33
    v_cvt_pk_bf16_f32 v181, v34, v35
    v_pk_fma_f32 v[36:37], v[140:141], v[174:175], v[36:37] op_sel:[0,0,0] op_sel_hi:[1,0,1]
    v_pk_fma_f32 v[38:39], v[142:143], v[174:175], v[38:39] op_sel:[0,0,0] op_sel_hi:[1,0,1]
    ds_write_b64 v7, v[180:181] offset:15616
    v_cvt_pk_bf16_f32 v182, v36, v37
    v_cvt_pk_bf16_f32 v183, v38, v39
    s_lshl_b32 s22, s54, 4
    s_cmp_eq_u32 s54, 30
    s_cselect_b32 s22, 85248, s22
    v_add_u32 v6, s22, v3
    v_pk_fma_f32 v[40:41], v[144:145], v[168:169], v[40:41] op_sel:[0,0,0] op_sel_hi:[1,0,1]
    v_pk_fma_f32 v[42:43], v[146:147], v[168:169], v[42:43] op_sel:[0,0,0] op_sel_hi:[1,0,1]
    ds_write_b64 v7, v[182:183] offset:23424
    v_cvt_pk_bf16_f32 v176, v40, v41
    v_cvt_pk_bf16_f32 v177, v42, v43
    v_pk_fma_f32 v[44:45], v[144:145], v[170:171], v[44:45] op_sel:[0,0,0] op_sel_hi:[1,0,1]
    v_pk_fma_f32 v[46:47], v[146:147], v[170:171], v[46:47] op_sel:[0,0,0] op_sel_hi:[1,0,1]
    ds_write_b64 v6, v[176:177] offset:0
    v_cvt_pk_bf16_f32 v178, v44, v45
    v_cvt_pk_bf16_f32 v179, v46, v47
    v_pk_fma_f32 v[48:49], v[144:145], v[172:173], v[48:49] op_sel:[0,0,0] op_sel_hi:[1,0,1]
    v_pk_fma_f32 v[50:51], v[146:147], v[172:173], v[50:51] op_sel:[0,0,0] op_sel_hi:[1,0,1]
    ds_write_b64 v6, v[178:179] offset:7808
    v_cvt_pk_bf16_f32 v180, v48, v49
    v_cvt_pk_bf16_f32 v181, v50, v51
    v_pk_fma_f32 v[52:53], v[144:145], v[174:175], v[52:53] op_sel:[0,0,0] op_sel_hi:[1,0,1]
    v_pk_fma_f32 v[54:55], v[146:147], v[174:175], v[54:55] op_sel:[0,0,0] op_sel_hi:[1,0,1]
    ds_write_b64 v6, v[180:181] offset:15616
    v_cvt_pk_bf16_f32 v182, v52, v53
    v_cvt_pk_bf16_f32 v183, v54, v55
    s_lshl_b32 s22, s55, 4
    s_cmp_eq_u32 s55, 30
    s_cselect_b32 s22, 85248, s22
    v_add_u32 v7, s22, v3
    v_pk_fma_f32 v[56:57], v[148:149], v[168:169], v[56:57] op_sel:[0,0,0] op_sel_hi:[1,0,1]
    v_pk_fma_f32 v[58:59], v[150:151], v[168:169], v[58:59] op_sel:[0,0,0] op_sel_hi:[1,0,1]
    ds_write_b64 v6, v[182:183] offset:23424
    v_cvt_pk_bf16_f32 v176, v56, v57
    v_cvt_pk_bf16_f32 v177, v58, v59
    v_pk_fma_f32 v[60:61], v[148:149], v[170:171], v[60:61] op_sel:[0,0,0] op_sel_hi:[1,0,1]
    v_pk_fma_f32 v[62:63], v[150:151], v[170:171], v[62:63] op_sel:[0,0,0] op_sel_hi:[1,0,1]
    ds_write_b64 v7, v[176:177] offset:0
    v_cvt_pk_bf16_f32 v178, v60, v61
    v_cvt_pk_bf16_f32 v179, v62, v63
    v_pk_fma_f32 v[64:65], v[148:149], v[172:173], v[64:65] op_sel:[0,0,0] op_sel_hi:[1,0,1]
    v_pk_fma_f32 v[66:67], v[150:151], v[172:173], v[66:67] op_sel:[0,0,0] op_sel_hi:[1,0,1]
    ds_write_b64 v7, v[178:179] offset:7808
    v_cvt_pk_bf16_f32 v180, v64, v65
    v_cvt_pk_bf16_f32 v181, v66, v67
    v_pk_fma_f32 v[68:69], v[148:149], v[174:175], v[68:69] op_sel:[0,0,0] op_sel_hi:[1,0,1]
    v_pk_fma_f32 v[70:71], v[150:151], v[174:175], v[70:71] op_sel:[0,0,0] op_sel_hi:[1,0,1]
    ds_write_b64 v7, v[180:181] offset:15616
    v_cvt_pk_bf16_f32 v182, v68, v69
    v_cvt_pk_bf16_f32 v183, v70, v71
    s_lshl_b32 s22, s56, 4
    s_cmp_eq_u32 s56, 30
    s_cselect_b32 s22, 85248, s22
    v_add_u32 v6, s22, v3
    v_pk_fma_f32 v[72:73], v[152:153], v[168:169], v[72:73] op_sel:[0,0,0] op_sel_hi:[1,0,1]
    v_pk_fma_f32 v[74:75], v[154:155], v[168:169], v[74:75] op_sel:[0,0,0] op_sel_hi:[1,0,1]
    ds_write_b64 v7, v[182:183] offset:23424
    v_cvt_pk_bf16_f32 v176, v72, v73
    v_cvt_pk_bf16_f32 v177, v74, v75
    v_pk_fma_f32 v[76:77], v[152:153], v[170:171], v[76:77] op_sel:[0,0,0] op_sel_hi:[1,0,1]
    v_pk_fma_f32 v[78:79], v[154:155], v[170:171], v[78:79] op_sel:[0,0,0] op_sel_hi:[1,0,1]
    ds_write_b64 v6, v[176:177] offset:0
    v_cvt_pk_bf16_f32 v178, v76, v77
    v_cvt_pk_bf16_f32 v179, v78, v79
    v_pk_fma_f32 v[80:81], v[152:153], v[172:173], v[80:81] op_sel:[0,0,0] op_sel_hi:[1,0,1]
    v_pk_fma_f32 v[82:83], v[154:155], v[172:173], v[82:83] op_sel:[0,0,0] op_sel_hi:[1,0,1]
    ds_write_b64 v6, v[178:179] offset:7808
    v_cvt_pk_bf16_f32 v180, v80, v81
    v_cvt_pk_bf16_f32 v181, v82, v83
    v_pk_fma_f32 v[84:85], v[152:153], v[174:175], v[84:85] op_sel:[0,0,0] op_sel_hi:[1,0,1]
    v_pk_fma_f32 v[86:87], v[154:155], v[174:175], v[86:87] op_sel:[0,0,0] op_sel_hi:[1,0,1]
    ds_write_b64 v6, v[180:181] offset:15616
    v_cvt_pk_bf16_f32 v182, v84, v85
    v_cvt_pk_bf16_f32 v183, v86, v87
    s_lshl_b32 s22, s57, 4
    s_cmp_eq_u32 s57, 30
    s_cselect_b32 s22, 85248, s22
    v_add_u32 v7, s22, v3
    v_pk_fma_f32 v[88:89], v[156:157], v[168:169], v[88:89] op_sel:[0,0,0] op_sel_hi:[1,0,1]
    v_pk_fma_f32 v[90:91], v[158:159], v[168:169], v[90:91] op_sel:[0,0,0] op_sel_hi:[1,0,1]
    ds_write_b64 v6, v[182:183] offset:23424
    v_cvt_pk_bf16_f32 v176, v88, v89
    v_cvt_pk_bf16_f32 v177, v90, v91
    v_pk_fma_f32 v[92:93], v[156:157], v[170:171], v[92:93] op_sel:[0,0,0] op_sel_hi:[1,0,1]
    v_pk_fma_f32 v[94:95], v[158:159], v[170:171], v[94:95] op_sel:[0,0,0] op_sel_hi:[1,0,1]
    ds_write_b64 v7, v[176:177] offset:0
    v_cvt_pk_bf16_f32 v178, v92, v93
    v_cvt_pk_bf16_f32 v179, v94, v95
    v_pk_fma_f32 v[96:97], v[156:157], v[172:173], v[96:97] op_sel:[0,0,0] op_sel_hi:[1,0,1]
    v_pk_fma_f32 v[98:99], v[158:159], v[172:173], v[98:99] op_sel:[0,0,0] op_sel_hi:[1,0,1]
    ds_write_b64 v7, v[178:179] offset:7808
    v_cvt_pk_bf16_f32 v180, v96, v97
    v_cvt_pk_bf16_f32 v181, v98, v99
    v_pk_fma_f32 v[100:101], v[156:157], v[174:175], v[100:101] op_sel:[0,0,0] op_sel_hi:[1,0,1]
    v_pk_fma_f32 v[102:103], v[158:159], v[174:175], v[102:103] op_sel:[0,0,0] op_sel_hi:[1,0,1]
    ds_write_b64 v7, v[180:181] offset:15616
    v_cvt_pk_bf16_f32 v182, v100, v101
    v_cvt_pk_bf16_f32 v183, v102, v103
    s_lshl_b32 s22, s58, 4
    s_cmp_eq_u32 s58, 30
    s_cselect_b32 s22, 85248, s22
    v_add_u32 v6, s22, v3
    v_pk_fma_f32 v[104:105], v[160:161], v[168:169], v[104:105] op_sel:[0,0,0] op_sel_hi:[1,0,1]
    v_pk_fma_f32 v[106:107], v[162:163], v[168:169], v[106:107] op_sel:[0,0,0] op_sel_hi:[1,0,1]
    ds_write_b64 v7, v[182:183] offset:23424
    v_cvt_pk_bf16_f32 v176, v104, v105
    v_cvt_pk_bf16_f32 v177, v106, v107
    v_pk_fma_f32 v[108:109], v[160:161], v[170:171], v[108:109] op_sel:[0,0,0] op_sel_hi:[1,0,1]
    v_pk_fma_f32 v[110:111], v[162:163], v[170:171], v[110:111] op_sel:[0,0,0] op_sel_hi:[1,0,1]
    ds_write_b64 v6, v[176:177] offset:0
    v_cvt_pk_bf16_f32 v178, v108, v109
    v_cvt_pk_bf16_f32 v179, v110, v111
    v_pk_fma_f32 v[112:113], v[160:161], v[172:173], v[112:113] op_sel:[0,0,0] op_sel_hi:[1,0,1]
    v_pk_fma_f32 v[114:115], v[162:163], v[172:173], v[114:115] op_sel:[0,0,0] op_sel_hi:[1,0,1]
    ds_write_b64 v6, v[178:179] offset:7808
    v_cvt_pk_bf16_f32 v180, v112, v113
    v_cvt_pk_bf16_f32 v181, v114, v115
    v_pk_fma_f32 v[116:117], v[160:161], v[174:175], v[116:117] op_sel:[0,0,0] op_sel_hi:[1,0,1]
    v_pk_fma_f32 v[118:119], v[162:163], v[174:175], v[118:119] op_sel:[0,0,0] op_sel_hi:[1,0,1]
    ds_write_b64 v6, v[180:181] offset:15616
    v_cvt_pk_bf16_f32 v182, v116, v117
    v_cvt_pk_bf16_f32 v183, v118, v119
    s_lshl_b32 s22, s59, 4
    s_cmp_eq_u32 s59, 30
    s_cselect_b32 s22, 85248, s22
    v_add_u32 v7, s22, v3
    v_pk_fma_f32 v[120:121], v[164:165], v[168:169], v[120:121] op_sel:[0,0,0] op_sel_hi:[1,0,1]
    v_pk_fma_f32 v[122:123], v[166:167], v[168:169], v[122:123] op_sel:[0,0,0] op_sel_hi:[1,0,1]
    ds_write_b64 v6, v[182:183] offset:23424
    v_cvt_pk_bf16_f32 v176, v120, v121
    v_cvt_pk_bf16_f32 v177, v122, v123
    v_pk_fma_f32 v[124:125], v[164:165], v[170:171], v[124:125] op_sel:[0,0,0] op_sel_hi:[1,0,1]
    v_pk_fma_f32 v[126:127], v[166:167], v[170:171], v[126:127] op_sel:[0,0,0] op_sel_hi:[1,0,1]
    ds_write_b64 v7, v[176:177] offset:0
    v_cvt_pk_bf16_f32 v178, v124, v125
    v_cvt_pk_bf16_f32 v179, v126, v127
    v_pk_fma_f32 v[128:129], v[164:165], v[172:173], v[128:129] op_sel:[0,0,0] op_sel_hi:[1,0,1]
    v_pk_fma_f32 v[130:131], v[166:167], v[172:173], v[130:131] op_sel:[0,0,0] op_sel_hi:[1,0,1]
    ds_write_b64 v7, v[178:179] offset:7808
    v_cvt_pk_bf16_f32 v180, v128, v129
    v_cvt_pk_bf16_f32 v181, v130, v131
    v_pk_fma_f32 v[132:133], v[164:165], v[174:175], v[132:133] op_sel:[0,0,0] op_sel_hi:[1,0,1]
    v_pk_fma_f32 v[134:135], v[166:167], v[174:175], v[134:135] op_sel:[0,0,0] op_sel_hi:[1,0,1]
    ds_write_b64 v7, v[180:181] offset:15616
    v_cvt_pk_bf16_f32 v182, v132, v133
    v_cvt_pk_bf16_f32 v183, v134, v135
    ds_write_b64 v7, v[182:183] offset:23424
    s_waitcnt lgkmcnt(0)
    s_branch fz_attn
fz_q_loader:
    s_sub_u32 s3, s19, 4
    v_lshrrev_b32 v3, 3, v0
    v_and_b32 v4, 7, v0
    v_xor_b32 v4, v4, v3
    v_mul_u32_u24 v3, 1280, v3
    v_lshl_add_u32 v3, v4, 4, v3
    s_mul_i32 s36, s15, 112
    s_mul_i32 s37, s3, 32
    s_add_u32 s36, s36, s37
    s_sub_u32 s36, s36, 16
    s_mul_i32 s36, s36, 1280
    v_add_u32 v3, s36, v3
    v_add_u32 v16, 0, v3
    v_add_u32 v17, 9216, v3
    v_add_u32 v18, 18432, v3
    v_add_u32 v19, 27648, v3
    v_lshrrev_b32 v5, 5, v0
    v_and_b32 v6, 31, v0
    v_lshlrev_b32 v7, 1, v5
    v_xor_b32 v6, v6, v7
    v_mul_u32_u24 v5, 3840, v5
    s_mul_i32 s37, s3, 61440
    s_mul_i32 s38, s14, 160
    s_add_u32 s37, s37, s38
    v_add_u32 v5, s37, v5
    s_movk_i32 s38, 1120
    v_xor_b32 v7, 0, v6
    v_min_u32 v7, 29, v7
    v_mul_u32_u24 v24, 205, v7
    v_lshrrev_b32 v24, 11, v24
    v_lshl_add_u32 v7, v7, 4, v5
    v_mad_u32_u24 v26, v24, s38, v7
    v_xor_b32 v7, 4, v6
    v_min_u32 v7, 29, v7
    v_mul_u32_u24 v24, 205, v7
    v_lshrrev_b32 v24, 11, v24
    v_lshl_add_u32 v7, v7, 4, v5
    v_mad_u32_u24 v27, v24, s38, v7
    v_xor_b32 v7, 8, v6
    v_min_u32 v7, 29, v7
    v_mul_u32_u24 v24, 205, v7
    v_lshrrev_b32 v24, 11, v24
    v_lshl_add_u32 v7, v7, 4, v5
    v_mad_u32_u24 v28, v24, s38, v7
    v_xor_b32 v7, 12, v6
    v_min_u32 v7, 29, v7
    v_mul_u32_u24 v24, 205, v7
    v_lshrrev_b32 v24, 11, v24
    v_lshl_add_u32 v7, v7, 4, v5
    v_mad_u32_u24 v29, v24, s38, v7
    v_add_u32 v8, 0, v26
    v_add_u32 v9, 6656, v27
    v_add_u32 v10, 13312, v26
    v_add_u32 v11, 19968, v27
    v_add_u32 v12, 30720, v28
    v_add_u32 v13, 37376, v29
    v_add_u32 v14, 44032, v28
    v_add_u32 v15, 50688, v29
    s_cmp_eq_u32 s3, 0
    s_cselect_b32 s50, 0xffffff00, -1
    s_mov_b32 s51, -1
    s_waitcnt lgkmcnt(0)
    s_mov_b32 s20, s4
    s_mov_b32 s21, s5
    s_mov_b32 s22, 2621440
    s_mov_b32 s23, 0x00020000
    s_mov_b32 s24, s6
    s_mov_b32 s25, s7
    s_mov_b32 s26, 2457600
    s_mov_b32 s27, 0x00020000
    s_mov_b32 s40, 0
    s_mov_b32 s41, 0
    s_mov_b32 s42, 0
    s_mul_i32 s43, s3, 4096
    s_mul_i32 s44, s3, 8192
    s_add_u32 s44, s44, 16384
    s_setprio 3
    s_add_u32 m0, s42, s44
    s_nop 0
    buffer_load_dwordx4 v8, s[24:27], s41 offen offset:0 lds
    buffer_load_dwordx4 v9, s[24:27], s41 offen offset:1024 lds
    buffer_load_dwordx4 v10, s[24:27], s41 offen offset:2048 lds
    buffer_load_dwordx4 v11, s[24:27], s41 offen offset:3072 lds
    s_add_u32 m0, m0, 4096
    s_nop 0
    buffer_load_dwordx4 v12, s[24:27], s41 offen offset:0 lds
    buffer_load_dwordx4 v13, s[24:27], s41 offen offset:1024 lds
    buffer_load_dwordx4 v14, s[24:27], s41 offen offset:2048 lds
    buffer_load_dwordx4 v15, s[24:27], s41 offen offset:3072 lds
    s_add_u32 m0, s42, s43
    s_add_u32 s41, s41, 245760
    s_mov_b64 exec, s[50:51]
    buffer_load_dwordx4 v16, s[20:23], s40 offen offset:0 lds
    s_mov_b64 exec, -1
    buffer_load_dwordx4 v17, s[20:23], s40 offen offset:1024 lds
    buffer_load_dwordx4 v18, s[20:23], s40 offen offset:2048 lds
    buffer_load_dwordx4 v19, s[20:23], s40 offen offset:3072 lds
    s_add_u32 s40, s40, 128
    s_add_u32 s42, s42, 49152
    s_cmp_eq_u32 s42, 147456
    s_cselect_b32 s42, 0, s42
    s_add_u32 m0, s42, s44
    s_nop 0
    buffer_load_dwordx4 v8, s[24:27], s41 offen offset:0 lds
    buffer_load_dwordx4 v9, s[24:27], s41 offen offset:1024 lds
    buffer_load_dwordx4 v10, s[24:27], s41 offen offset:2048 lds
    buffer_load_dwordx4 v11, s[24:27], s41 offen offset:3072 lds
    s_add_u32 m0, m0, 4096
    s_nop 0
    buffer_load_dwordx4 v12, s[24:27], s41 offen offset:0 lds
    buffer_load_dwordx4 v13, s[24:27], s41 offen offset:1024 lds
    v_mov_b32 v56, 0
    v_mov_b32 v57, 0
    v_mov_b32 v58, 0
    v_mov_b32 v59, 0
    v_mov_b32 v60, 0
    v_mov_b32 v61, 0
    v_mov_b32 v62, 0
    v_mov_b32 v63, 0
    v_mov_b32 v68, 0
    v_mov_b32 v69, 0
    v_mov_b32 v70, 0
    v_mov_b32 v71, 0
    v_mov_b32 v72, 0
    v_mov_b32 v73, 0
    v_mov_b32 v74, 0
    v_mov_b32 v75, 0
    v_mov_b32 v80, 0x3f803f80
    v_mov_b32 v81, 0x3f803f80
    v_mov_b32 v82, 0x3f803f80
    v_mov_b32 v83, 0x3f803f80
    v_and_b32 v3, 15, v0
    v_lshrrev_b32 v4, 4, v0
    v_and_b32 v5, 7, v3
    v_xor_b32 v5, v5, v4
    v_lshlrev_b32 v6, 7, v3
    v_lshl_add_u32 v6, v5, 4, v6
    s_lshl_b32 s47, s3, 1
    s_lshl_b32 s36, s47, 11
    v_add_u32 v1, s36, v6
    v_xor_b32 v2, 64, v1
    s_mov_b32 s45, 0
    s_waitcnt vmcnt(6)
    s_barrier
    buffer_load_dwordx4 v14, s[24:27], s41 offen offset:2048 lds
    buffer_load_dwordx4 v15, s[24:27], s41 offen offset:3072 lds
    s_add_u32 m0, s42, s43
    s_add_u32 s41, s41, 245760
    s_mov_b64 exec, s[50:51]
    buffer_load_dwordx4 v16, s[20:23], s40 offen offset:0 lds
    s_mov_b64 exec, -1
    buffer_load_dwordx4 v17, s[20:23], s40 offen offset:1024 lds
    buffer_load_dwordx4 v18, s[20:23], s40 offen offset:2048 lds
    buffer_load_dwordx4 v19, s[20:23], s40 offen offset:3072 lds
    s_add_u32 s40, s40, 128
    s_add_u32 s42, s42, 49152
    s_cmp_eq_u32 s42, 147456
    s_cselect_b32 s42, 0, s42
    v_add_u32 v3, s45, v1
    v_add_u32 v4, s45, v2
    ds_read_b128 v[32:35], v3 offset:0
    ds_read_b128 v[36:39], v3 offset:2048
    ds_read_b128 v[40:43], v4 offset:0
    ds_read_b128 v[44:47], v4 offset:2048
    s_add_u32 s45, s45, 49152
    s_cmp_eq_u32 s45, 147456
    s_cselect_b32 s45, 0, s45
    s_add_u32 m0, s42, s44
    s_nop 0
    buffer_load_dwordx4 v8, s[24:27], s41 offen offset:0 lds
    s_waitcnt lgkmcnt(3)
    buffer_load_dwordx4 v9, s[24:27], s41 offen offset:1024 lds
    v_mfma_f32_16x16x32_bf16 v[56:59], v[32:35], v[32:35], v[56:59]
    buffer_load_dwordx4 v10, s[24:27], s41 offen offset:2048 lds
    v_mfma_f32_16x16x32_bf16 v[68:71], v[80:83], v[32:35], v[68:71]
    buffer_load_dwordx4 v11, s[24:27], s41 offen offset:3072 lds
    s_waitcnt lgkmcnt(2)
    s_add_u32 m0, m0, 4096
    s_nop 0
    buffer_load_dwordx4 v12, s[24:27], s41 offen offset:0 lds
    v_mfma_f32_16x16x32_bf16 v[60:63], v[36:39], v[36:39], v[60:63]
    buffer_load_dwordx4 v13, s[24:27], s41 offen offset:1024 lds
    v_mfma_f32_16x16x32_bf16 v[72:75], v[80:83], v[36:39], v[72:75]
    buffer_load_dwordx4 v14, s[24:27], s41 offen offset:2048 lds
    s_waitcnt lgkmcnt(1)
    buffer_load_dwordx4 v15, s[24:27], s41 offen offset:3072 lds
    v_mfma_f32_16x16x32_bf16 v[56:59], v[40:43], v[40:43], v[56:59]
    s_add_u32 m0, s42, s43
    s_add_u32 s41, s41, 245760
    s_mov_b64 exec, s[50:51]
    buffer_load_dwordx4 v16, s[20:23], s40 offen offset:0 lds
    s_mov_b64 exec, -1
    buffer_load_dwordx4 v17, s[20:23], s40 offen offset:1024 lds
    buffer_load_dwordx4 v18, s[20:23], s40 offen offset:2048 lds
    v_mfma_f32_16x16x32_bf16 v[68:71], v[80:83], v[40:43], v[68:71]
    buffer_load_dwordx4 v19, s[20:23], s40 offen offset:3072 lds
    s_waitcnt lgkmcnt(0)
    s_add_u32 s40, s40, 128
    s_add_u32 s42, s42, 49152
    s_cmp_eq_u32 s42, 147456
    s_cselect_b32 s42, 0, s42
    v_mfma_f32_16x16x32_bf16 v[60:63], v[44:47], v[44:47], v[60:63]
    v_mfma_f32_16x16x32_bf16 v[72:75], v[80:83], v[44:47], v[72:75]
    s_mov_b32 s46, 7
fz_q_lloop:
    s_waitcnt vmcnt(12)
    s_barrier
    v_add_u32 v3, s45, v1
    v_add_u32 v4, s45, v2
    ds_read_b128 v[32:35], v3 offset:0
    ds_read_b128 v[36:39], v3 offset:2048
    ds_read_b128 v[40:43], v4 offset:0
    ds_read_b128 v[44:47], v4 offset:2048
    s_add_u32 s45, s45, 49152
    s_cmp_eq_u32 s45, 147456
    s_cselect_b32 s45, 0, s45
    s_add_u32 m0, s42, s44
    s_nop 0
    buffer_load_dwordx4 v8, s[24:27], s41 offen offset:0 lds
    s_waitcnt lgkmcnt(3)
    buffer_load_dwordx4 v9, s[24:27], s41 offen offset:1024 lds
    v_mfma_f32_16x16x32_bf16 v[56:59], v[32:35], v[32:35], v[56:59]
    buffer_load_dwordx4 v10, s[24:27], s41 offen offset:2048 lds
    v_mfma_f32_16x16x32_bf16 v[68:71], v[80:83], v[32:35], v[68:71]
    buffer_load_dwordx4 v11, s[24:27], s41 offen offset:3072 lds
    s_waitcnt lgkmcnt(2)
    s_add_u32 m0, m0, 4096
    s_nop 0
    buffer_load_dwordx4 v12, s[24:27], s41 offen offset:0 lds
    v_mfma_f32_16x16x32_bf16 v[60:63], v[36:39], v[36:39], v[60:63]
    buffer_load_dwordx4 v13, s[24:27], s41 offen offset:1024 lds
    v_mfma_f32_16x16x32_bf16 v[72:75], v[80:83], v[36:39], v[72:75]
    buffer_load_dwordx4 v14, s[24:27], s41 offen offset:2048 lds
    s_waitcnt lgkmcnt(1)
    buffer_load_dwordx4 v15, s[24:27], s41 offen offset:3072 lds
    v_mfma_f32_16x16x32_bf16 v[56:59], v[40:43], v[40:43], v[56:59]
    s_add_u32 m0, s42, s43
    s_add_u32 s41, s41, 245760
    s_mov_b64 exec, s[50:51]
    buffer_load_dwordx4 v16, s[20:23], s40 offen offset:0 lds
    s_mov_b64 exec, -1
    buffer_load_dwordx4 v17, s[20:23], s40 offen offset:1024 lds
    buffer_load_dwordx4 v18, s[20:23], s40 offen offset:2048 lds
    v_mfma_f32_16x16x32_bf16 v[68:71], v[80:83], v[40:43], v[68:71]
    buffer_load_dwordx4 v19, s[20:23], s40 offen offset:3072 lds
    s_waitcnt lgkmcnt(0)
    s_add_u32 s40, s40, 128
    s_add_u32 s42, s42, 49152
    s_cmp_eq_u32 s42, 147456
    s_cselect_b32 s42, 0, s42
    v_mfma_f32_16x16x32_bf16 v[60:63], v[44:47], v[44:47], v[60:63]
    v_mfma_f32_16x16x32_bf16 v[72:75], v[80:83], v[44:47], v[72:75]
    s_sub_u32 s46, s46, 1
    s_cmp_lg_u32 s46, 0
    s_cbranch_scc1 fz_q_lloop
    s_waitcnt vmcnt(12)
    s_barrier
    v_add_u32 v3, s45, v1
    v_add_u32 v4, s45, v2
    ds_read_b128 v[32:35], v3 offset:0
    ds_read_b128 v[36:39], v3 offset:2048
    ds_read_b128 v[40:43], v4 offset:0
    ds_read_b128 v[44:47], v4 offset:2048
    s_add_u32 s45, s45, 49152
    s_cmp_eq_u32 s45, 147456
    s_cselect_b32 s45, 0, s45
    s_waitcnt lgkmcnt(3)
    v_mfma_f32_16x16x32_bf16 v[56:59], v[32:35], v[32:35], v[56:59]
    v_mfma_f32_16x16x32_bf16 v[68:71], v[80:83], v[32:35], v[68:71]
    s_waitcnt lgkmcnt(2)
    v_mfma_f32_16x16x32_bf16 v[60:63], v[36:39], v[36:39], v[60:63]
    v_mfma_f32_16x16x32_bf16 v[72:75], v[80:83], v[36:39], v[72:75]
    s_waitcnt lgkmcnt(1)
    v_mfma_f32_16x16x32_bf16 v[56:59], v[40:43], v[40:43], v[56:59]
    v_mfma_f32_16x16x32_bf16 v[68:71], v[80:83], v[40:43], v[68:71]
    s_waitcnt lgkmcnt(0)
    v_mfma_f32_16x16x32_bf16 v[60:63], v[44:47], v[44:47], v[60:63]
    v_mfma_f32_16x16x32_bf16 v[72:75], v[80:83], v[44:47], v[72:75]
    s_and_b32 s22, s19, 3
    s_lshr_b32 s23, s19, 2
    v_lshrrev_b32 v3, 2, v0
    v_and_b32 v4, 3, v0
    v_and_b32 v5, 1, v3
    v_lshrrev_b32 v6, 1, v3
    v_lshl_add_u32 v7, v6, 3, v5
    s_lshl_b32 s24, s23, 6
    v_add_u32 v7, s24, v7
    v_lshl_add_u32 v12, v4, 1, v7
    s_mul_i32 s25, s22, 40
    v_mul_u32_u24 v13, 488, v12
    v_add_u32 v13, s25, v13
    v_add_u32 v216, 7808, v13
    v_add_u32 v217, 160, v13
    v_mul_u32_u24 v13, 176, v12
    v_add_u32 v13, s25, v13
    v_add_u32 v219, 65536, v13
    v_lshrrev_b32 v13, 4, v0
    v_lshl_add_u32 v13, v13, 2, v4
    v_and_b32 v14, 1, v13
    v_lshrrev_b32 v13, 1, v13
    v_lshl_add_u32 v13, v13, 3, v14
    v_add_u32 v13, s24, v13
    v_and_b32 v14, 3, v3
    v_lshl_add_u32 v13, v14, 1, v13
    v_mul_u32_u24 v13, 488, v13
    v_add_u32 v13, s25, v13
    v_add_u32 v218, 320, v13
    s_mul_i32 s26, s15, 112
    v_add_u32 v12, s26, v7
    v_sub_u32 v12, 17, v12
    v_ashrrev_i32 v12, 1, v12
    v_add_u32 v13, 1, v4
    v_max_i32 v12, v12, v13
    v_add_u32 v13, 8, v4
    v_sub_u32 v13, v13, v12
    v_mov_b32 v14, 0xf149f2ca
    v_mov_b32 v15, 0
    v_sub_u32 v5, 1, v12
    v_cmp_le_u32 vcc, v5, v13
    s_nop 1
    v_cndmask_b32 v220, v14, v15, vcc
    v_sub_u32 v5, 2, v12
    v_cmp_le_u32 vcc, v5, v13
    s_nop 1
    v_cndmask_b32 v221, v14, v15, vcc
    v_sub_u32 v5, 3, v12
    v_cmp_le_u32 vcc, v5, v13
    s_nop 1
    v_cndmask_b32 v222, v14, v15, vcc
    v_sub_u32 v5, 4, v12
    v_cmp_le_u32 vcc, v5, v13
    s_nop 1
    v_cndmask_b32 v223, v14, v15, vcc
    v_sub_u32 v5, 5, v12
    v_cmp_le_u32 vcc, v5, v13
    s_nop 1
    v_cndmask_b32 v224, v14, v15, vcc
    v_sub_u32 v5, 6, v12
    v_cmp_le_u32 vcc, v5, v13
    s_nop 1
    v_cndmask_b32 v225, v14, v15, vcc
    v_sub_u32 v5, 7, v12
    v_cmp_le_u32 vcc, v5, v13
    s_nop 1
    v_cndmask_b32 v226, v14, v15, vcc
    v_sub_u32 v5, 8, v12
    v_cmp_le_u32 vcc, v5, v13
    s_nop 1
    v_cndmask_b32 v227, v14, v15, vcc
    v_sub_u32 v5, 9, v12
    v_cmp_le_u32 vcc, v5, v13
    s_nop 1
    v_cndmask_b32 v228, v14, v15, vcc
    v_sub_u32 v5, 10, v12
    v_cmp_le_u32 vcc, v5, v13
    s_nop 1
    v_cndmask_b32 v229, v14, v15, vcc
    v_sub_u32 v5, 11, v12
    v_cmp_le_u32 vcc, v5, v13
    s_nop 1
    v_cndmask_b32 v230, v14, v15, vcc
    v_lshrrev_b32 v3, 4, v0
    v_and_b32 v4, 15, v0
    s_mul_i32 s26, s15, 7
    s_mul_i32 s27, s14, 10
    s_lshl_b32 s25, s19, 2
    s_add_u32 s25, s25, 0
    v_add_u32 v5, s25, v3
    v_mul_u32_u24 v6, 205, v5
    v_lshrrev_b32 v6, 11, v6
    v_mul_u32_u24 v7, 10, v6
    v_sub_u32 v7, v5, v7
    v_lshl_add_u32 v12, v6, 4, v4
    v_mul_u32_u24 v12, 176, v12
    v_lshl_add_u32 v12, v7, 4, v12
    v_add_u32 v232, 65536, v12
    v_add_u32 v7, s27, v7
    v_add_u32 v12, s26, v6
    v_mul_u32_u24 v12, 68, v12
    v_lshrrev_b32 v13, 2, v7
    v_add_u32 v12, v12, v13
    v_lshlrev_b32 v12, 10, v12
    v_and_b32 v13, 3, v7
    v_lshl_add_u32 v13, v13, 4, v4
    v_lshl_add_u32 v12, v13, 4, v12
    v_cmp_gt_u32 vcc, 70, v5
    v_mov_b32 v13, 0x80000000
    s_nop 0
    v_cndmask_b32 v236, v13, v12, vcc
    s_lshl_b32 s25, s19, 2
    s_add_u32 s25, s25, 32
    v_add_u32 v5, s25, v3
    v_mul_u32_u24 v6, 205, v5
    v_lshrrev_b32 v6, 11, v6
    v_mul_u32_u24 v7, 10, v6
    v_sub_u32 v7, v5, v7
    v_lshl_add_u32 v12, v6, 4, v4
    v_mul_u32_u24 v12, 176, v12
    v_lshl_add_u32 v12, v7, 4, v12
    v_add_u32 v233, 65536, v12
    v_add_u32 v7, s27, v7
    v_add_u32 v12, s26, v6
    v_mul_u32_u24 v12, 68, v12
    v_lshrrev_b32 v13, 2, v7
    v_add_u32 v12, v12, v13
    v_lshlrev_b32 v12, 10, v12
    v_and_b32 v13, 3, v7
    v_lshl_add_u32 v13, v13, 4, v4
    v_lshl_add_u32 v12, v13, 4, v12
    v_cmp_gt_u32 vcc, 70, v5
    v_mov_b32 v13, 0x80000000
    s_nop 0
    v_cndmask_b32 v237, v13, v12, vcc
    s_lshl_b32 s25, s19, 2
    s_add_u32 s25, s25, 64
    v_add_u32 v5, s25, v3
    v_mul_u32_u24 v6, 205, v5
    v_lshrrev_b32 v6, 11, v6
    v_mul_u32_u24 v7, 10, v6
    v_sub_u32 v7, v5, v7
    v_lshl_add_u32 v12, v6, 4, v4
    v_mul_u32_u24 v12, 176, v12
    v_lshl_add_u32 v12, v7, 4, v12
    v_add_u32 v234, 65536, v12
    v_add_u32 v7, s27, v7
    v_add_u32 v12, s26, v6
    v_mul_u32_u24 v12, 68, v12
    v_lshrrev_b32 v13, 2, v7
    v_add_u32 v12, v12, v13
    v_lshlrev_b32 v12, 10, v12
    v_and_b32 v13, 3, v7
    v_lshl_add_u32 v13, v13, 4, v4
    v_lshl_add_u32 v12, v13, 4, v12
    v_cmp_gt_u32 vcc, 70, v5
    v_mov_b32 v13, 0x80000000
    s_nop 0
    v_cndmask_b32 v238, v13, v12, vcc
    s_waitcnt vmcnt(0)
    s_barrier
    v_add_u32 v3, s45, v1
    v_add_u32 v4, s45, v2
    ds_read_b128 v[32:35], v3 offset:0
    ds_read_b128 v[36:39], v3 offset:2048
    ds_read_b128 v[40:43], v4 offset:0
    ds_read_b128 v[44:47], v4 offset:2048
    s_add_u32 s45, s45, 49152
    s_cmp_eq_u32 s45, 147456
    s_cselect_b32 s45, 0, s45
    s_waitcnt lgkmcnt(3)
    v_mfma_f32_16x16x32_bf16 v[56:59], v[32:35], v[32:35], v[56:59]
    v_mfma_f32_16x16x32_bf16 v[68:71], v[80:83], v[32:35], v[68:71]
    s_waitcnt lgkmcnt(2)
    v_mfma_f32_16x16x32_bf16 v[60:63], v[36:39], v[36:39], v[60:63]
    v_mfma_f32_16x16x32_bf16 v[72:75], v[80:83], v[36:39], v[72:75]
    s_waitcnt lgkmcnt(1)
    v_mfma_f32_16x16x32_bf16 v[56:59], v[40:43], v[40:43], v[56:59]
    v_mfma_f32_16x16x32_bf16 v[68:71], v[80:83], v[40:43], v[68:71]
    s_waitcnt lgkmcnt(0)
    v_mfma_f32_16x16x32_bf16 v[60:63], v[44:47], v[44:47], v[60:63]
    v_mfma_f32_16x16x32_bf16 v[72:75], v[80:83], v[44:47], v[72:75]
    s_mov_b32 s52, 0x22222222
    s_mov_b32 s53, 0x22222222
    s_mov_b32 s54, 0x44444444
    s_mov_b32 s55, 0x44444444
    s_mov_b32 s56, 0x88888888
    s_mov_b32 s57, 0x88888888
    s_nop 7
    v_cndmask_b32 v56, v56, v57, s[52:53]
    v_cndmask_b32 v56, v56, v58, s[54:55]
    v_cndmask_b32 v56, v56, v59, s[56:57]
    v_cndmask_b32 v60, v60, v61, s[52:53]
    v_cndmask_b32 v60, v60, v62, s[54:55]
    v_cndmask_b32 v60, v60, v63, s[56:57]
    v_mul_f32 v68, 0x3acccccd, v68
    v_mul_f32 v72, 0x3acccccd, v72
    v_mul_f32 v56, 0x3acccccd, v56
    v_mul_f32 v60, 0x3acccccd, v60
    v_fma_f32 v56, -v68, v68, v56
    v_fma_f32 v60, -v72, v72, v60
    v_max_f32 v56, 0, v56
    v_max_f32 v60, 0, v60
    v_cvt_pk_bf16_f32 v68, v68, v68
    v_lshlrev_b32 v68, 16, v68
    v_cvt_pk_bf16_f32 v56, v56, v56
    v_lshlrev_b32 v56, 16, v56
    v_cvt_pk_bf16_f32 v72, v72, v72
    v_lshlrev_b32 v72, 16, v72
    v_cvt_pk_bf16_f32 v60, v60, v60
    v_lshlrev_b32 v60, 16, v60
    v_add_f32 v56, 0x3727c5ac, v56
    v_add_f32 v60, 0x3727c5ac, v60
    v_cvt_pk_bf16_f32 v56, v56, v56
    v_lshlrev_b32 v56, 16, v56
    v_cvt_pk_bf16_f32 v60, v60, v60
    v_lshlrev_b32 v60, 16, v60
    v_sqrt_f32 v56, v56
    v_sqrt_f32 v60, v60
    s_nop 0
    v_cvt_pk_bf16_f32 v56, v56, v56
    v_lshlrev_b32 v56, 16, v56
    v_cvt_pk_bf16_f32 v60, v60, v60
    v_lshlrev_b32 v60, 16, v60
    v_rcp_f32 v69, v56
    v_rcp_f32 v73, v60
    v_and_b32 v3, 15, v0
    v_lshlrev_b32 v3, 3, v3
    v_mul_f32 v68, v68, v69
    v_mul_f32 v72, v72, v73
    v_sub_f32 v68, 0, v68
    v_sub_f32 v72, 0, v72
    s_lshl_b32 s36, s47, 7
    s_add_u32 s36, s36, 147456
    v_add_u32 v3, s36, v3
    s_mov_b32 s52, 0x00f0000f
    s_mov_b32 s53, 0xf0000f00
    s_mov_b64 exec, s[52:53]
    ds_write_b64 v3, v[68:69] offset:0
    ds_write_b64 v3, v[72:73] offset:128
    s_mov_b64 exec, -1
    s_waitcnt lgkmcnt(0)
    s_barrier
    s_barrier
    s_mov_b32 s84, s34
    s_mov_b32 s85, s35
    s_mov_b32 s86, 256
    s_mov_b32 s87, 0x00020000
    v_mov_b32 v3, 128
    s_mov_b32 s83, 20000
fz_nonce_q:
    buffer_load_dword v4, v3, s[84:87], 0 offen sc1
    s_waitcnt vmcnt(0)
    v_readfirstlane_b32 s82, v4
    s_nop 3
    s_cmp_lg_u32 s82, 0
    s_cbranch_scc1 fz_nonce_ok_q
    s_sleep 2
    s_sub_u32 s83, s83, 1
    s_cmp_lg_u32 s83, 0
    s_cbranch_scc1 fz_nonce_q
fz_nonce_ok_q:
    s_and_b32 s12, s2, 7
    s_lshr_b32 s13, s2, 3
    s_and_b32 s14, s12, 1
    s_lshl_b32 s14, s14, 2
    s_and_b32 s16, s13, 3
    s_add_u32 s14, s14, s16
    s_lshr_b32 s15, s12, 1
    s_lshl_b32 s15, s15, 3
    s_lshr_b32 s16, s13, 2
    s_add_u32 s15, s15, s16
    v_lshlrev_b32 v2, 4, v0
    s_mov_b32 s20, s10
    s_mov_b32 s21, s11
    s_mov_b32 s22, 8912896
    s_mov_b32 s23, 0x00020000
    s_add_u32 s24, s10, 8912896
    s_addc_u32 s25, s11, 0
    s_mov_b32 s26, 2785280
    s_mov_b32 s27, 0x00020000
    s_lshl_b32 s40, s15, 2
    s_add_u32 s40, s40, s3
    s_mul_i32 s40, s40, 69632
    s_mul_i32 s41, s14, 348160
    s_mul_i32 s43, s3, 5120
    s_add_u32 s41, s41, s43
    s_lshl_b32 s44, s3, 12
    s_add_u32 s44, s44, 20480
    s_mov_b32 s42, 0
    s_mov_b32 s45, 0
    s_lshl_b32 s36, s15, 6
    s_add_u32 s37, s36, 63
    s_mul_hi_u32 s46, s36, 38347923
    s_mul_hi_u32 s47, s37, 38347923
    v_and_b32 v5, 7, v0
    v_mov_b32 v7, s46
    v_mov_b32 v8, s47
    v_cmp_le_u32 vcc, 8, v0
    s_nop 1
    v_cndmask_b32 v7, v7, v8, vcc
    v_and_b32 v8, 1, v5
    v_lshl_add_u32 v7, v7, 1, v8
    v_cmp_le_u32 vcc, 19, v7
    v_subrev_u32 v10, 19, v7
    v_mov_b32 v9, 0
    v_mov_b32 v11, 4
    v_cndmask_b32 v7, v7, v10, vcc
    v_cndmask_b32 v9, v9, v11, vcc
    v_add_u32 v7, 0, v7
    v_lshrrev_b32 v5, 1, v5
    v_add_u32 v5, v5, v9
    v_lshl_add_u32 v7, v7, 3, v5
    v_lshlrev_b32 v240, 7, v7
    v_mov_b32 v241, v2
fz_attn:
    s_mov_b32 s28, s10
    s_mov_b32 s29, s11
    s_mov_b32 s30, 8912896
    s_mov_b32 s31, 0x00020000
    s_mov_b32 s38, 0x3ea52b5c
    s_barrier
    ds_read_b64 v[28:29], v216 offset:0
    ds_read_b64 v[30:31], v216 offset:8
    ds_read_b64 v[32:33], v216 offset:16
    ds_read_b64 v[34:35], v216 offset:24
    ds_read_b64 v[36:37], v216 offset:32
    ds_read_b64 v[40:41], v217 offset:0
    ds_read_b64 v[50:51], v217 offset:3904
    ds_read_b64 v[60:61], v217 offset:7808
    ds_read_b64 v[42:43], v217 offset:8
    ds_read_b64 v[52:53], v217 offset:3912
    ds_read_b64 v[62:63], v217 offset:7816
    ds_read_b64 v[44:45], v217 offset:16
    ds_read_b64 v[54:55], v217 offset:3920
    ds_read_b64 v[64:65], v217 offset:7824
    s_waitcnt lgkmcnt(6)
    ds_read_b64 v[46:47], v217 offset:24
    ds_read_b64 v[56:57], v217 offset:3928
    ds_read_b64 v[66:67], v217 offset:7832
    ds_read_b64 v[48:49], v217 offset:32
    ds_read_b64 v[58:59], v217 offset:3936
    ds_read_b64 v[68:69], v217 offset:7840
    v_mfma_f32_4x4x4_16b_bf16 v[72:75], v[40:41], v[28:29], 0
    v_mfma_f32_4x4x4_16b_bf16 v[76:79], v[50:51], v[28:29], 0
    v_mfma_f32_4x4x4_16b_bf16 v[80:83], v[60:61], v[28:29], 0
    s_waitcnt lgkmcnt(9)
    v_mfma_f32_4x4x4_16b_bf16 v[72:75], v[42:43], v[30:31], v[72:75]
    v_mfma_f32_4x4x4_16b_bf16 v[76:79], v[52:53], v[30:31], v[76:79]
    v_mfma_f32_4x4x4_16b_bf16 v[80:83], v[62:63], v[30:31], v[80:83]
    s_waitcnt lgkmcnt(6)
    v_mfma_f32_4x4x4_16b_bf16 v[72:75], v[44:45], v[32:33], v[72:75]
    v_mfma_f32_4x4x4_16b_bf16 v[76:79], v[54:55], v[32:33], v[76:79]
    v_mfma_f32_4x4x4_16b_bf16 v[80:83], v[64:65], v[32:33], v[80:83]
    ds_read_b64_tr_b16 v[84:85], v218 offset:0
    ds_read_b64_tr_b16 v[86:87], v218 offset:8
    ds_read_b64_tr_b16 v[88:89], v218 offset:16
    ds_read_b64_tr_b16 v[90:91], v218 offset:24
    ds_read_b64_tr_b16 v[92:93], v218 offset:32
    ds_read_b64_tr_b16 v[94:95], v218 offset:3904
    s_waitcnt lgkmcnt(9)
    v_mfma_f32_4x4x4_16b_bf16 v[72:75], v[46:47], v[34:35], v[72:75]
    v_mfma_f32_4x4x4_16b_bf16 v[76:79], v[56:57], v[34:35], v[76:79]
    v_mfma_f32_4x4x4_16b_bf16 v[80:83], v[66:67], v[34:35], v[80:83]
    s_waitcnt lgkmcnt(6)
    v_mfma_f32_4x4x4_16b_bf16 v[72:75], v[48:49], v[36:37], v[72:75]
    v_mfma_f32_4x4x4_16b_bf16 v[76:79], v[58:59], v[36:37], v[76:79]
    v_mfma_f32_4x4x4_16b_bf16 v[80:83], v[68:69], v[36:37], v[80:83]
    ds_read_b64_tr_b16 v[96:97], v218 offset:3912
    ds_read_b64_tr_b16 v[98:99], v218 offset:3920
    ds_read_b64_tr_b16 v[100:101], v218 offset:3928
    ds_read_b64_tr_b16 v[102:103], v218 offset:3936
    ds_read_b64_tr_b16 v[104:105], v218 offset:7808
    ds_read_b64_tr_b16 v[106:107], v218 offset:7816
    ds_read_b64_tr_b16 v[108:109], v218 offset:7824
    ds_read_b64_tr_b16 v[110:111], v218 offset:7832
    ds_read_b64_tr_b16 v[112:113], v218 offset:7840
    s_nop 1
    v_fma_f32 v73, v73, s38, v220
    v_fma_f32 v74, v74, s38, v221
    v_fma_f32 v75, v75, s38, v222
    v_fma_f32 v76, v76, s38, v223
    v_fma_f32 v77, v77, s38, v224
    v_fma_f32 v78, v78, s38, v225
    v_fma_f32 v79, v79, s38, v226
    v_fma_f32 v80, v80, s38, v227
    v_fma_f32 v81, v81, s38, v228
    v_fma_f32 v82, v82, s38, v229
    v_fma_f32 v83, v83, s38, v230
    v_max3_f32 v14, v73, v74, v75
    v_max3_f32 v15, v76, v77, v78
    v_max3_f32 v14, v14, v79, v80
    v_max3_f32 v15, v15, v81, v82
    v_max3_f32 v14, v14, v15, v83
    v_sub_f32 v73, v73, v14
    v_sub_f32 v74, v74, v14
    v_sub_f32 v75, v75, v14
    v_sub_f32 v76, v76, v14
    v_sub_f32 v77, v77, v14
    v_sub_f32 v78, v78, v14
    v_sub_f32 v79, v79, v14
    v_sub_f32 v80, v80, v14
    v_sub_f32 v81, v81, v14
    v_sub_f32 v82, v82, v14
    v_sub_f32 v83, v83, v14
    v_exp_f32 v73, v73
    v_exp_f32 v74, v74
    v_exp_f32 v75, v75
    v_exp_f32 v76, v76
    v_exp_f32 v77, v77
    v_exp_f32 v78, v78
    v_exp_f32 v79, v79
    v_exp_f32 v80, v80
    v_exp_f32 v81, v81
    v_exp_f32 v82, v82
    v_exp_f32 v83, v83
    v_add_f32 v14, v73, v74
    v_add_f32 v15, v75, v76
    v_add_f32 v14, v14, v77
    v_add_f32 v15, v15, v78
    v_add_f32 v14, v14, v79
    v_add_f32 v15, v15, v80
    v_add_f32 v14, v14, v81
    v_add_f32 v15, v15, v82
    v_add_f32 v14, v14, v83
    v_add_f32 v14, v14, v15
    v_rcp_f32 v14, v14
    v_mov_b32 v72, 0
    v_mul_f32 v73, v73, v14
    v_mul_f32 v74, v74, v14
    v_mul_f32 v75, v75, v14
    v_mul_f32 v76, v76, v14
    v_mul_f32 v77, v77, v14
    v_mul_f32 v78, v78, v14
    v_mul_f32 v79, v79, v14
    v_mul_f32 v80, v80, v14
    v_mul_f32 v81, v81, v14
    v_mul_f32 v82, v82, v14
    v_mul_f32 v83, v83, v14
    v_cvt_pk_bf16_f32 v28, v72, v73
    v_cvt_pk_bf16_f32 v29, v74, v75
    v_cvt_pk_bf16_f32 v30, v76, v77
    v_cvt_pk_bf16_f32 v31, v78, v79
    v_cvt_pk_bf16_f32 v32, v80, v81
    v_cvt_pk_bf16_f32 v33, v82, v83
    s_waitcnt lgkmcnt(0)
    s_nop 0
    v_mfma_f32_4x4x4_16b_bf16 v[40:43], v[84:85], v[28:29], 0
    v_mfma_f32_4x4x4_16b_bf16 v[44:47], v[86:87], v[28:29], 0
    v_mfma_f32_4x4x4_16b_bf16 v[48:51], v[88:89], v[28:29], 0
    v_mfma_f32_4x4x4_16b_bf16 v[52:55], v[90:91], v[28:29], 0
    v_mfma_f32_4x4x4_16b_bf16 v[56:59], v[92:93], v[28:29], 0
    v_mfma_f32_4x4x4_16b_bf16 v[40:43], v[94:95], v[30:31], v[40:43]
    v_mfma_f32_4x4x4_16b_bf16 v[44:47], v[96:97], v[30:31], v[44:47]
    v_mfma_f32_4x4x4_16b_bf16 v[48:51], v[98:99], v[30:31], v[48:51]
    v_mfma_f32_4x4x4_16b_bf16 v[52:55], v[100:101], v[30:31], v[52:55]
    v_mfma_f32_4x4x4_16b_bf16 v[56:59], v[102:103], v[30:31], v[56:59]
    v_mfma_f32_4x4x4_16b_bf16 v[40:43], v[104:105], v[32:33], v[40:43]
    v_mfma_f32_4x4x4_16b_bf16 v[44:47], v[106:107], v[32:33], v[44:47]
    v_mfma_f32_4x4x4_16b_bf16 v[48:51], v[108:109], v[32:33], v[48:51]
    v_mfma_f32_4x4x4_16b_bf16 v[52:55], v[110:111], v[32:33], v[52:55]
    v_mfma_f32_4x4x4_16b_bf16 v[56:59], v[112:113], v[32:33], v[56:59]
    s_nop 1
    v_cvt_pk_bf16_f32 v60, v40, v41
    v_cvt_pk_bf16_f32 v61, v42, v43
    ds_write_b64 v219, v[60:61] offset:0
    v_cvt_pk_bf16_f32 v62, v44, v45
    v_cvt_pk_bf16_f32 v63, v46, v47
    ds_write_b64 v219, v[62:63] offset:8
    v_cvt_pk_bf16_f32 v64, v48, v49
    v_cvt_pk_bf16_f32 v65, v50, v51
    ds_write_b64 v219, v[64:65] offset:16
    v_cvt_pk_bf16_f32 v66, v52, v53
    v_cvt_pk_bf16_f32 v67, v54, v55
    ds_write_b64 v219, v[66:67] offset:24
    v_cvt_pk_bf16_f32 v68, v56, v57
    v_cvt_pk_bf16_f32 v69, v58, v59
    ds_write_b64 v219, v[68:69] offset:32
    s_waitcnt lgkmcnt(0)
    s_barrier
    ds_read_b128 v[80:83], v232
    ds_read_b128 v[84:87], v233
    ds_read_b128 v[88:91], v234
    s_waitcnt lgkmcnt(2)
    buffer_store_dwordx4 v[80:83], v236, s[28:31], 0 offen sc1
    s_waitcnt lgkmcnt(1)
    buffer_store_dwordx4 v[84:87], v237, s[28:31], 0 offen sc1
    s_waitcnt lgkmcnt(0)
    buffer_store_dwordx4 v[88:91], v238, s[28:31], 0 offen sc1
    s_cmp_lt_u32 s19, 4
    s_cbranch_scc1 fz_phase2
    v_mov_b32 v2, v241
    s_waitcnt vmcnt(0)
    s_barrier
    s_add_u32 s84, s10, 11698176
    s_addc_u32 s85, s11, 0
    s_mov_b32 s86, 36864
    s_mov_b32 s87, 0x00020000
    s_and_b32 s36, s2, 31
    s_lshl_b32 s36, s36, 7
    s_add_u32 s36, s36, 32768
    v_mov_b32 v3, s36
    s_mov_b32 s83, 20000
fz_p2_wt_pollq:
    buffer_load_dword v4, v3, s[84:87], 0 offen sc1
    s_waitcnt vmcnt(0)
    v_readfirstlane_b32 s36, v4
    s_nop 3
    s_cmp_eq_u32 s36, s82
    s_cbranch_scc1 fz_p2_wt_okq
    s_sleep 8
    s_sub_u32 s83, s83, 1
    s_cmp_lg_u32 s83, 0
    s_cbranch_scc1 fz_p2_wt_pollq
fz_p2_wt_okq:
    s_add_u32 m0, s42, s43
    s_add_u32 s39, s41, 4096
    buffer_load_dwordx4 v2, s[24:27], s41 offen offset:0 lds
    buffer_load_dwordx4 v2, s[24:27], s41 offen offset:1024 lds
    buffer_load_dwordx4 v2, s[24:27], s41 offen offset:2048 lds
    buffer_load_dwordx4 v2, s[24:27], s41 offen offset:3072 lds
    s_add_u32 m0, m0, 4096
    s_add_u32 s41, s41, 20480
    buffer_load_dwordx4 v2, s[24:27], s39 offen lds
    s_add_u32 s42, s42, 36864
    s_cmp_eq_u32 s42, 147456
    s_cselect_b32 s42, 0, s42
    s_add_u32 m0, s42, s43
    s_add_u32 s39, s41, 4096
    buffer_load_dwordx4 v2, s[24:27], s41 offen offset:0 lds
    buffer_load_dwordx4 v2, s[24:27], s41 offen offset:1024 lds
    buffer_load_dwordx4 v2, s[24:27], s41 offen offset:2048 lds
    buffer_load_dwordx4 v2, s[24:27], s41 offen offset:3072 lds
    s_add_u32 m0, m0, 4096
    s_add_u32 s41, s41, 20480
    buffer_load_dwordx4 v2, s[24:27], s39 offen lds
    s_add_u32 s42, s42, 36864
    s_cmp_eq_u32 s42, 147456
    s_cselect_b32 s42, 0, s42
    s_add_u32 m0, s42, s43
    s_add_u32 s39, s41, 4096
    buffer_load_dwordx4 v2, s[24:27], s41 offen offset:0 lds
    buffer_load_dwordx4 v2, s[24:27], s41 offen offset:1024 lds
    buffer_load_dwordx4 v2, s[24:27], s41 offen offset:2048 lds
    buffer_load_dwordx4 v2, s[24:27], s41 offen offset:3072 lds
    s_add_u32 m0, m0, 4096
    s_add_u32 s41, s41, 20480
    buffer_load_dwordx4 v2, s[24:27], s39 offen lds
    s_add_u32 s42, s42, 36864
    s_cmp_eq_u32 s42, 147456
    s_cselect_b32 s42, 0, s42
    s_mov_b32 s83, 20000
fz_pf_qq:
    buffer_load_dword v4, v240, s[84:87], 0 offen sc1
    s_waitcnt vmcnt(0)
    v_cmp_ne_u32 vcc, s82, v4
    s_nop 4
    s_and_b32 s36, vcc_lo, 0xffff
    s_cmp_eq_u32 s36, 0
    s_cbranch_scc1 fz_pf_ok_qq
    s_sleep 16
    s_sub_u32 s83, s83, 1
    s_cmp_lg_u32 s83, 0
    s_cbranch_scc1 fz_pf_qq
fz_pf_ok_qq:
    s_add_u32 m0, s45, s44
    s_add_u32 s45, s45, 36864
    buffer_load_dwordx4 v2, s[20:23], s40 offen offset:0 lds
    buffer_load_dwordx4 v2, s[20:23], s40 offen offset:1024 lds
    buffer_load_dwordx4 v2, s[20:23], s40 offen offset:2048 lds
    buffer_load_dwordx4 v2, s[20:23], s40 offen offset:3072 lds
    s_add_u32 s40, s40, 4096
    s_cmp_eq_u32 s45, 147456
    s_cselect_b32 s45, 0, s45
    s_add_u32 m0, s45, s44
    s_add_u32 s45, s45, 36864
    buffer_load_dwordx4 v2, s[20:23], s40 offen offset:0 lds
    buffer_load_dwordx4 v2, s[20:23], s40 offen offset:1024 lds
    buffer_load_dwordx4 v2, s[20:23], s40 offen offset:2048 lds
    buffer_load_dwordx4 v2, s[20:23], s40 offen offset:3072 lds
    s_add_u32 s40, s40, 4096
    s_cmp_eq_u32 s45, 147456
    s_cselect_b32 s45, 0, s45
    s_add_u32 m0, s45, s44
    s_add_u32 s45, s45, 36864
    buffer_load_dwordx4 v2, s[20:23], s40 offen offset:0 lds
    buffer_load_dwordx4 v2, s[20:23], s40 offen offset:1024 lds
    buffer_load_dwordx4 v2, s[20:23], s40 offen offset:2048 lds
    buffer_load_dwordx4 v2, s[20:23], s40 offen offset:3072 lds
    s_add_u32 s40, s40, 4096
    s_cmp_eq_u32 s45, 147456
    s_cselect_b32 s45, 0, s45
    s_branch fz_p2_lcommon
fz_ffn:
    s_sub_u32 s17, s17, 19
    s_mul_i32 s16, s16, 13
    s_add_u32 s16, s16, s17
    s_lshr_b32 s15, s16, 1
    s_and_b32 s16, s16, 1
    s_add_u32 s14, s14, s16
    s_cmp_ge_u32 s19, 4
    s_cbranch_scc1 fz_f_loader
    s_mov_b32 s3, s19
    s_or_b32 s22, s17, s19
    s_cmp_lg_u32 s22, 0
    s_cbranch_scc1 fz_f_pfskip
    s_getpc_b64 s[60:61]
pf_f:
    v_lshlrev_b32 v250, 7, v0
    v_add_u32 v251, 0, v250
    v_min_u32 v251, text_end-pf_f-4, v251
    global_load_dword v252, v251, s[60:61]
    v_add_u32 v251, 8192, v250
    v_min_u32 v251, text_end-pf_f-4, v251
    global_load_dword v252, v251, s[60:61]
    v_add_u32 v251, 16384, v250
    v_min_u32 v251, text_end-pf_f-4, v251
    global_load_dword v252, v251, s[60:61]
    v_add_u32 v251, 24576, v250
    v_min_u32 v251, text_end-pf_f-4, v251
    global_load_dword v252, v251, s[60:61]
fz_f_pfskip:
    s_and_b32 s20, s3, 1
    s_lshr_b32 s21, s3, 1
    v_and_b32 v3, 15, v0
    v_lshrrev_b32 v4, 4, v0
    v_and_b32 v5, 7, v3
    v_xor_b32 v5, v5, v4
    v_lshlrev_b32 v6, 7, v3
    v_lshl_add_u32 v6, v5, 4, v6
    s_mul_i32 s22, s20, 10240
    v_add_u32 v218, s22, v6
    v_xor_b32 v219, 64, v218
    v_lshrrev_b32 v5, 2, v0
    v_and_b32 v5, 3, v5
    v_and_b32 v6, 3, v0
    v_lshl_add_u32 v7, v4, 3, v5
    v_mul_u32_u24 v7, 384, v7
    v_and_b32 v3, 1, v6
    v_lshl_add_u32 v7, v3, 3, v7
    v_add_u32 v7, 20480, v7
    v_lshrrev_b32 v6, 1, v6
    v_and_b32 v3, 1, v4
    v_and_b32 v5, 2, v5
    v_lshl_or_b32 v5, v3, 2, v5
    v_or_b32 v6, v6, v5
    s_mul_i32 s22, s21, 6
    s_mul_i32 s23, s20, 2
    s_add_u32 s24, s23, 0
    s_cmp_ge_u32 s24, 6
    s_cselect_b32 s25, 6, 0
    s_sub_u32 s24, s24, s25
    s_add_u32 s24, s24, s22
    s_lshl_b32 s52, s24, 1
    v_xor_b32 v3, s52, v6
    v_lshl_add_u32 v212, v3, 4, v7
    s_add_u32 s24, s23, 1
    s_cmp_ge_u32 s24, 6
    s_cselect_b32 s25, 6, 0
    s_sub_u32 s24, s24, s25
    s_add_u32 s24, s24, s22
    s_lshl_b32 s53, s24, 1
    v_xor_b32 v3, s53, v6
    v_lshl_add_u32 v213, v3, 4, v7
    s_add_u32 s24, s23, 2
    s_cmp_ge_u32 s24, 6
    s_cselect_b32 s25, 6, 0
    s_sub_u32 s24, s24, s25
    s_add_u32 s24, s24, s22
    s_lshl_b32 s54, s24, 1
    v_xor_b32 v3, s54, v6
    v_lshl_add_u32 v214, v3, 4, v7
    s_add_u32 s24, s23, 3
    s_cmp_ge_u32 s24, 6
    s_cselect_b32 s25, 6, 0
    s_sub_u32 s24, s24, s25
    s_add_u32 s24, s24, s22
    s_lshl_b32 s55, s24, 1
    v_xor_b32 v3, s55, v6
    v_lshl_add_u32 v215, v3, 4, v7
    s_add_u32 s24, s23, 4
    s_cmp_ge_u32 s24, 6
    s_cselect_b32 s25, 6, 0
    s_sub_u32 s24, s24, s25
    s_add_u32 s24, s24, s22
    s_lshl_b32 s56, s24, 1
    v_xor_b32 v3, s56, v6
    v_lshl_add_u32 v216, v3, 4, v7
    s_add_u32 s24, s23, 5
    s_cmp_ge_u32 s24, 6
    s_cselect_b32 s25, 6, 0
    s_sub_u32 s24, s24, s25
    s_add_u32 s24, s24, s22
    s_lshl_b32 s57, s24, 1
    v_xor_b32 v3, s57, v6
    v_lshl_add_u32 v217, v3, 4, v7
    v_mov_b32 v8, 0
    v_mov_b32 v9, 0
    v_mov_b32 v10, 0
    v_mov_b32 v11, 0
    v_mov_b32 v12, 0
    v_mov_b32 v13, 0
    v_mov_b32 v14, 0
    v_mov_b32 v15, 0
    v_mov_b32 v16, 0
    v_mov_b32 v17, 0
    v_mov_b32 v18, 0
    v_mov_b32 v19, 0
    v_mov_b32 v20, 0
    v_mov_b32 v21, 0
    v_mov_b32 v22, 0
    v_mov_b32 v23, 0
    v_mov_b32 v24, 0
    v_mov_b32 v25, 0
    v_mov_b32 v26, 0
    v_mov_b32 v27, 0
    v_mov_b32 v28, 0
    v_mov_b32 v29, 0
    v_mov_b32 v30, 0
    v_mov_b32 v31, 0
    v_mov_b32 v32, 0
    v_mov_b32 v33, 0
    v_mov_b32 v34, 0
    v_mov_b32 v35, 0
    v_mov_b32 v36, 0
    v_mov_b32 v37, 0
    v_mov_b32 v38, 0
    v_mov_b32 v39, 0
    v_mov_b32 v40, 0
    v_mov_b32 v41, 0
    v_mov_b32 v42, 0
    v_mov_b32 v43, 0
    v_mov_b32 v44, 0
    v_mov_b32 v45, 0
    v_mov_b32 v46, 0
    v_mov_b32 v47, 0
    v_mov_b32 v48, 0
    v_mov_b32 v49, 0
    v_mov_b32 v50, 0
    v_mov_b32 v51, 0
    v_mov_b32 v52, 0
    v_mov_b32 v53, 0
    v_mov_b32 v54, 0
    v_mov_b32 v55, 0
    v_mov_b32 v56, 0
    v_mov_b32 v57, 0
    v_mov_b32 v58, 0
    v_mov_b32 v59, 0
    v_mov_b32 v60, 0
    v_mov_b32 v61, 0
    v_mov_b32 v62, 0
    v_mov_b32 v63, 0
    v_mov_b32 v64, 0
    v_mov_b32 v65, 0
    v_mov_b32 v66, 0
    v_mov_b32 v67, 0
    v_mov_b32 v68, 0
    v_mov_b32 v69, 0
    v_mov_b32 v70, 0
    v_mov_b32 v71, 0
    v_mov_b32 v72, 0
    v_mov_b32 v73, 0
    v_mov_b32 v74, 0
    v_mov_b32 v75, 0
    v_mov_b32 v76, 0
    v_mov_b32 v77, 0
    v_mov_b32 v78, 0
    v_mov_b32 v79, 0
    v_mov_b32 v80, 0
    v_mov_b32 v81, 0
    v_mov_b32 v82, 0
    v_mov_b32 v83, 0
    v_mov_b32 v84, 0
    v_mov_b32 v85, 0
    v_mov_b32 v86, 0
    v_mov_b32 v87, 0
    v_mov_b32 v88, 0
    v_mov_b32 v89, 0
    v_mov_b32 v90, 0
    v_mov_b32 v91, 0
    v_mov_b32 v92, 0
    v_mov_b32 v93, 0
    v_mov_b32 v94, 0
    v_mov_b32 v95, 0
    v_mov_b32 v96, 0
    v_mov_b32 v97, 0
    v_mov_b32 v98, 0
    v_mov_b32 v99, 0
    v_mov_b32 v100, 0
    v_mov_b32 v101, 0
    v_mov_b32 v102, 0
    v_mov_b32 v103, 0
    v_mov_b32 v104, 0
    v_mov_b32 v105, 0
    v_mov_b32 v106, 0
    v_mov_b32 v107, 0
    v_mov_b32 v108, 0
    v_mov_b32 v109, 0
    v_mov_b32 v110, 0
    v_mov_b32 v111, 0
    v_mov_b32 v112, 0
    v_mov_b32 v113, 0
    v_mov_b32 v114, 0
    v_mov_b32 v115, 0
    v_mov_b32 v116, 0
    v_mov_b32 v117, 0
    v_mov_b32 v118, 0
    v_mov_b32 v119, 0
    v_mov_b32 v120, 0
    v_mov_b32 v121, 0
    v_mov_b32 v122, 0
    v_mov_b32 v123, 0
    v_mov_b32 v124, 0
    v_mov_b32 v125, 0
    v_mov_b32 v126, 0
    v_mov_b32 v127, 0
    v_mov_b32 v128, 0
    v_mov_b32 v129, 0
    v_mov_b32 v130, 0
    v_mov_b32 v131, 0
    v_mov_b32 v132, 0
    v_mov_b32 v133, 0
    v_mov_b32 v134, 0
    v_mov_b32 v135, 0
    v_mov_b32 v136, 0
    v_mov_b32 v137, 0
    v_mov_b32 v138, 0
    v_mov_b32 v139, 0
    v_mov_b32 v140, 0
    v_mov_b32 v141, 0
    v_mov_b32 v142, 0
    v_mov_b32 v143, 0
    v_mov_b32 v208, 0x3f803f80
    v_mov_b32 v209, 0x3f803f80
    v_mov_b32 v210, 0x3f803f80
    v_mov_b32 v211, 0x3f803f80
    s_waitcnt lgkmcnt(0)
    s_mov_b32 s17, 0
    s_barrier
    ds_read_b128 v[168:171], v218 offset:0
    ds_read_b128 v[172:175], v218 offset:2048
    ds_read_b128 v[176:179], v218 offset:4096
    ds_read_b128 v[180:183], v218 offset:6144
    ds_read_b128 v[184:187], v218 offset:8192
    ds_read_b64_tr_b16 v[144:145], v212 offset:0
    ds_read_b64_tr_b16 v[146:147], v212 offset:1536
    ds_read_b64_tr_b16 v[148:149], v213 offset:0
    ds_read_b64_tr_b16 v[150:151], v213 offset:1536
    ds_read_b64_tr_b16 v[152:153], v214 offset:0
    ds_read_b64_tr_b16 v[154:155], v214 offset:1536
    ds_read_b64_tr_b16 v[156:157], v215 offset:0
    ds_read_b64_tr_b16 v[158:159], v215 offset:1536
    s_waitcnt lgkmcnt(4)
    ds_read_b64_tr_b16 v[160:161], v216 offset:0
    ds_read_b64_tr_b16 v[162:163], v216 offset:1536
    s_waitcnt lgkmcnt(0)
    s_mov_b32 s18, 10
fz_f_cloop:
    s_waitcnt lgkmcnt(8)
    v_mfma_f32_16x16x32_bf16 v[8:11], v[144:147], v[168:171], v[8:11]
    v_mfma_f32_16x16x32_bf16 v[12:15], v[144:147], v[172:175], v[12:15]
    ds_read_b64_tr_b16 v[164:165], v217 offset:0
    v_mfma_f32_16x16x32_bf16 v[16:19], v[144:147], v[176:179], v[16:19]
    v_mfma_f32_16x16x32_bf16 v[20:23], v[144:147], v[180:183], v[20:23]
    ds_read_b64_tr_b16 v[166:167], v217 offset:1536
    v_mfma_f32_16x16x32_bf16 v[24:27], v[144:147], v[184:187], v[24:27]
    v_mfma_f32_16x16x32_bf16 v[128:131], v[144:147], v[208:211], v[128:131]
    ds_read_b128 v[188:191], v219 offset:0
    s_waitcnt lgkmcnt(9)
    v_mfma_f32_16x16x32_bf16 v[28:31], v[148:151], v[168:171], v[28:31]
    v_mfma_f32_16x16x32_bf16 v[32:35], v[148:151], v[172:175], v[32:35]
    ds_read_b64_tr_b16 v[144:145], v212 offset:12288
    v_mfma_f32_16x16x32_bf16 v[36:39], v[148:151], v[176:179], v[36:39]
    v_mfma_f32_16x16x32_bf16 v[40:43], v[148:151], v[180:183], v[40:43]
    ds_read_b64_tr_b16 v[146:147], v212 offset:13824
    v_mfma_f32_16x16x32_bf16 v[44:47], v[148:151], v[184:187], v[44:47]
    v_mfma_f32_16x16x32_bf16 v[132:135], v[148:151], v[208:211], v[132:135]
    ds_read_b128 v[192:195], v219 offset:2048
    s_waitcnt lgkmcnt(10)
    v_mfma_f32_16x16x32_bf16 v[48:51], v[152:155], v[168:171], v[48:51]
    v_mfma_f32_16x16x32_bf16 v[52:55], v[152:155], v[172:175], v[52:55]
    ds_read_b64_tr_b16 v[148:149], v213 offset:12288
    v_mfma_f32_16x16x32_bf16 v[56:59], v[152:155], v[176:179], v[56:59]
    v_mfma_f32_16x16x32_bf16 v[60:63], v[152:155], v[180:183], v[60:63]
    ds_read_b64_tr_b16 v[150:151], v213 offset:13824
    v_mfma_f32_16x16x32_bf16 v[64:67], v[152:155], v[184:187], v[64:67]
    v_mfma_f32_16x16x32_bf16 v[136:139], v[152:155], v[208:211], v[136:139]
    ds_read_b128 v[196:199], v219 offset:4096
    s_waitcnt lgkmcnt(11)
    v_mfma_f32_16x16x32_bf16 v[68:71], v[156:159], v[168:171], v[68:71]
    v_mfma_f32_16x16x32_bf16 v[72:75], v[156:159], v[172:175], v[72:75]
    ds_read_b64_tr_b16 v[152:153], v214 offset:12288
    v_mfma_f32_16x16x32_bf16 v[76:79], v[156:159], v[176:179], v[76:79]
    v_mfma_f32_16x16x32_bf16 v[80:83], v[156:159], v[180:183], v[80:83]
    ds_read_b64_tr_b16 v[154:155], v214 offset:13824
    v_mfma_f32_16x16x32_bf16 v[84:87], v[156:159], v[184:187], v[84:87]
    v_mfma_f32_16x16x32_bf16 v[140:143], v[156:159], v[208:211], v[140:143]
    ds_read_b128 v[200:203], v219 offset:6144
    s_waitcnt lgkmcnt(12)
    v_mfma_f32_16x16x32_bf16 v[88:91], v[160:163], v[168:171], v[88:91]
    v_mfma_f32_16x16x32_bf16 v[92:95], v[160:163], v[172:175], v[92:95]
    ds_read_b64_tr_b16 v[156:157], v215 offset:12288
    v_mfma_f32_16x16x32_bf16 v[96:99], v[160:163], v[176:179], v[96:99]
    v_mfma_f32_16x16x32_bf16 v[100:103], v[160:163], v[180:183], v[100:103]
    ds_read_b64_tr_b16 v[158:159], v215 offset:13824
    v_mfma_f32_16x16x32_bf16 v[104:107], v[160:163], v[184:187], v[104:107]
    s_waitcnt lgkmcnt(10)
    ds_read_b128 v[204:207], v219 offset:8192
    v_mfma_f32_16x16x32_bf16 v[108:111], v[164:167], v[168:171], v[108:111]
    v_mfma_f32_16x16x32_bf16 v[112:115], v[164:167], v[172:175], v[112:115]
    v_mfma_f32_16x16x32_bf16 v[116:119], v[164:167], v[176:179], v[116:119]
    ds_read_b64_tr_b16 v[160:161], v216 offset:12288
    v_mfma_f32_16x16x32_bf16 v[120:123], v[164:167], v[180:183], v[120:123]
    v_mfma_f32_16x16x32_bf16 v[124:127], v[164:167], v[184:187], v[124:127]
    ds_read_b64_tr_b16 v[162:163], v216 offset:13824
    s_waitcnt lgkmcnt(2)
    v_mfma_f32_16x16x32_bf16 v[8:11], v[144:147], v[188:191], v[8:11]
    ds_read_b64_tr_b16 v[164:165], v217 offset:12288
    v_mfma_f32_16x16x32_bf16 v[12:15], v[144:147], v[192:195], v[12:15]
    ds_read_b64_tr_b16 v[166:167], v217 offset:13824
    v_mfma_f32_16x16x32_bf16 v[16:19], v[144:147], v[196:199], v[16:19]
    s_add_u32 s17, s17, 45056
    s_cmp_eq_u32 s17, 135168
    v_mfma_f32_16x16x32_bf16 v[20:23], v[144:147], v[200:203], v[20:23]
    s_cselect_b32 s22, 135168, 0
    v_mfma_f32_16x16x32_bf16 v[24:27], v[144:147], v[204:207], v[24:27]
    s_sub_u32 s23, 45056, s22
    v_mfma_f32_16x16x32_bf16 v[128:131], v[144:147], v[208:211], v[128:131]
    s_sub_u32 s17, s17, s22
    v_add_u32 v212, s23, v212
    v_mfma_f32_16x16x32_bf16 v[28:31], v[148:151], v[188:191], v[28:31]
    v_add_u32 v213, s23, v213
    v_mfma_f32_16x16x32_bf16 v[32:35], v[148:151], v[192:195], v[32:35]
    v_add_u32 v214, s23, v214
    v_mfma_f32_16x16x32_bf16 v[36:39], v[148:151], v[196:199], v[36:39]
    v_add_u32 v215, s23, v215
    v_mfma_f32_16x16x32_bf16 v[40:43], v[148:151], v[200:203], v[40:43]
    v_add_u32 v216, s23, v216
    v_mfma_f32_16x16x32_bf16 v[44:47], v[148:151], v[204:207], v[44:47]
    v_add_u32 v218, s23, v218
    v_mfma_f32_16x16x32_bf16 v[132:135], v[148:151], v[208:211], v[132:135]
    v_add_u32 v219, s23, v219
    v_add_u32 v217, s23, v217
    s_waitcnt lgkmcnt(0)
    s_barrier
    v_mfma_f32_16x16x32_bf16 v[48:51], v[152:155], v[188:191], v[48:51]
    v_mfma_f32_16x16x32_bf16 v[52:55], v[152:155], v[192:195], v[52:55]
    ds_read_b128 v[168:171], v218 offset:0
    v_mfma_f32_16x16x32_bf16 v[56:59], v[152:155], v[196:199], v[56:59]
    ds_read_b128 v[172:175], v218 offset:2048
    v_mfma_f32_16x16x32_bf16 v[60:63], v[152:155], v[200:203], v[60:63]
    ds_read_b128 v[176:179], v218 offset:4096
    v_mfma_f32_16x16x32_bf16 v[64:67], v[152:155], v[204:207], v[64:67]
    ds_read_b128 v[180:183], v218 offset:6144
    v_mfma_f32_16x16x32_bf16 v[136:139], v[152:155], v[208:211], v[136:139]
    ds_read_b128 v[184:187], v218 offset:8192
    v_mfma_f32_16x16x32_bf16 v[68:71], v[156:159], v[188:191], v[68:71]
    v_mfma_f32_16x16x32_bf16 v[72:75], v[156:159], v[192:195], v[72:75]
    ds_read_b64_tr_b16 v[144:145], v212 offset:0
    v_mfma_f32_16x16x32_bf16 v[76:79], v[156:159], v[196:199], v[76:79]
    ds_read_b64_tr_b16 v[146:147], v212 offset:1536
    v_mfma_f32_16x16x32_bf16 v[80:83], v[156:159], v[200:203], v[80:83]
    ds_read_b64_tr_b16 v[148:149], v213 offset:0
    v_mfma_f32_16x16x32_bf16 v[84:87], v[156:159], v[204:207], v[84:87]
    ds_read_b64_tr_b16 v[150:151], v213 offset:1536
    v_mfma_f32_16x16x32_bf16 v[140:143], v[156:159], v[208:211], v[140:143]
    ds_read_b64_tr_b16 v[152:153], v214 offset:0
    v_mfma_f32_16x16x32_bf16 v[88:91], v[160:163], v[188:191], v[88:91]
    v_mfma_f32_16x16x32_bf16 v[92:95], v[160:163], v[192:195], v[92:95]
    ds_read_b64_tr_b16 v[154:155], v214 offset:1536
    v_mfma_f32_16x16x32_bf16 v[96:99], v[160:163], v[196:199], v[96:99]
    v_mfma_f32_16x16x32_bf16 v[100:103], v[160:163], v[200:203], v[100:103]
    ds_read_b64_tr_b16 v[156:157], v215 offset:0
    v_mfma_f32_16x16x32_bf16 v[104:107], v[160:163], v[204:207], v[104:107]
    ds_read_b64_tr_b16 v[158:159], v215 offset:1536
    v_mfma_f32_16x16x32_bf16 v[108:111], v[164:167], v[188:191], v[108:111]
    v_mfma_f32_16x16x32_bf16 v[112:115], v[164:167], v[192:195], v[112:115]
    v_mfma_f32_16x16x32_bf16 v[116:119], v[164:167], v[196:199], v[116:119]
    ds_read_b64_tr_b16 v[160:161], v216 offset:0
    v_mfma_f32_16x16x32_bf16 v[120:123], v[164:167], v[200:203], v[120:123]
    v_mfma_f32_16x16x32_bf16 v[124:127], v[164:167], v[204:207], v[124:127]
    s_waitcnt lgkmcnt(10)
    ds_read_b64_tr_b16 v[162:163], v216 offset:1536
    s_sub_u32 s18, s18, 1
    s_cmp_lg_u32 s18, 0
    s_cbranch_scc1 fz_f_cloop
    s_waitcnt lgkmcnt(0)
    v_and_b32 v3, 15, v0
    v_lshlrev_b32 v3, 3, v3
    s_mul_i32 s22, s20, 640
    s_add_u32 s22, s22, 151552
    v_add_u32 v3, s22, v3
    ds_read_b64 v[168:169], v3 offset:0
    ds_read_b64 v[170:171], v3 offset:128
    ds_read_b64 v[172:173], v3 offset:256
    ds_read_b64 v[174:175], v3 offset:384
    ds_read_b64 v[176:177], v3 offset:512
    v_lshrrev_b32 v4, 4, v0
    v_lshlrev_b32 v5, 4, v4
    v_add_u32 v5, 152832, v5
    s_lshl_b32 s22, s52, 5
    v_add_u32 v212, s22, v5
    s_lshl_b32 s22, s53, 5
    v_add_u32 v213, s22, v5
    s_lshl_b32 s22, s54, 5
    v_add_u32 v214, s22, v5
    s_lshl_b32 s22, s55, 5
    v_add_u32 v215, s22, v5
    s_lshl_b32 s22, s56, 5
    v_add_u32 v216, s22, v5
    s_lshl_b32 s22, s57, 5
    v_add_u32 v217, s22, v5
    s_mov_b32 s50, 0x00010001
    s_mov_b32 s51, 0x00010001
    s_mov_b64 exec, s[50:51]
    ds_write_b128 v212, v[128:131]
    ds_write_b128 v213, v[132:135]
    ds_write_b128 v214, v[136:139]
    ds_write_b128 v215, v[140:143]
    s_mov_b64 exec, -1
    s_waitcnt lgkmcnt(4)
    v_pk_mul_f32 v[8:9], v[8:9], v[168:169] op_sel:[0,1] op_sel_hi:[1,1]
    v_pk_mul_f32 v[10:11], v[10:11], v[168:169] op_sel:[0,1] op_sel_hi:[1,1]
    v_pk_mul_f32 v[12:13], v[12:13], v[170:171] op_sel:[0,1] op_sel_hi:[1,1]
    v_pk_mul_f32 v[14:15], v[14:15], v[170:171] op_sel:[0,1] op_sel_hi:[1,1]
    v_pk_mul_f32 v[16:17], v[16:17], v[172:173] op_sel:[0,1] op_sel_hi:[1,1]
    v_pk_mul_f32 v[18:19], v[18:19], v[172:173] op_sel:[0,1] op_sel_hi:[1,1]
    v_pk_mul_f32 v[20:21], v[20:21], v[174:175] op_sel:[0,1] op_sel_hi:[1,1]
    v_pk_mul_f32 v[22:23], v[22:23], v[174:175] op_sel:[0,1] op_sel_hi:[1,1]
    v_pk_mul_f32 v[24:25], v[24:25], v[176:177] op_sel:[0,1] op_sel_hi:[1,1]
    v_pk_mul_f32 v[26:27], v[26:27], v[176:177] op_sel:[0,1] op_sel_hi:[1,1]
    v_pk_mul_f32 v[28:29], v[28:29], v[168:169] op_sel:[0,1] op_sel_hi:[1,1]
    v_pk_mul_f32 v[30:31], v[30:31], v[168:169] op_sel:[0,1] op_sel_hi:[1,1]
    v_pk_mul_f32 v[32:33], v[32:33], v[170:171] op_sel:[0,1] op_sel_hi:[1,1]
    v_pk_mul_f32 v[34:35], v[34:35], v[170:171] op_sel:[0,1] op_sel_hi:[1,1]
    v_pk_mul_f32 v[36:37], v[36:37], v[172:173] op_sel:[0,1] op_sel_hi:[1,1]
    v_pk_mul_f32 v[38:39], v[38:39], v[172:173] op_sel:[0,1] op_sel_hi:[1,1]
    v_pk_mul_f32 v[40:41], v[40:41], v[174:175] op_sel:[0,1] op_sel_hi:[1,1]
    v_pk_mul_f32 v[42:43], v[42:43], v[174:175] op_sel:[0,1] op_sel_hi:[1,1]
    v_pk_mul_f32 v[44:45], v[44:45], v[176:177] op_sel:[0,1] op_sel_hi:[1,1]
    v_pk_mul_f32 v[46:47], v[46:47], v[176:177] op_sel:[0,1] op_sel_hi:[1,1]
    v_pk_mul_f32 v[48:49], v[48:49], v[168:169] op_sel:[0,1] op_sel_hi:[1,1]
    v_pk_mul_f32 v[50:51], v[50:51], v[168:169] op_sel:[0,1] op_sel_hi:[1,1]
    v_pk_mul_f32 v[52:53], v[52:53], v[170:171] op_sel:[0,1] op_sel_hi:[1,1]
    v_pk_mul_f32 v[54:55], v[54:55], v[170:171] op_sel:[0,1] op_sel_hi:[1,1]
    v_pk_mul_f32 v[56:57], v[56:57], v[172:173] op_sel:[0,1] op_sel_hi:[1,1]
    v_pk_mul_f32 v[58:59], v[58:59], v[172:173] op_sel:[0,1] op_sel_hi:[1,1]
    v_pk_mul_f32 v[60:61], v[60:61], v[174:175] op_sel:[0,1] op_sel_hi:[1,1]
    v_pk_mul_f32 v[62:63], v[62:63], v[174:175] op_sel:[0,1] op_sel_hi:[1,1]
    v_pk_mul_f32 v[64:65], v[64:65], v[176:177] op_sel:[0,1] op_sel_hi:[1,1]
    v_pk_mul_f32 v[66:67], v[66:67], v[176:177] op_sel:[0,1] op_sel_hi:[1,1]
    v_pk_mul_f32 v[68:69], v[68:69], v[168:169] op_sel:[0,1] op_sel_hi:[1,1]
    v_pk_mul_f32 v[70:71], v[70:71], v[168:169] op_sel:[0,1] op_sel_hi:[1,1]
    v_pk_mul_f32 v[72:73], v[72:73], v[170:171] op_sel:[0,1] op_sel_hi:[1,1]
    v_pk_mul_f32 v[74:75], v[74:75], v[170:171] op_sel:[0,1] op_sel_hi:[1,1]
    v_pk_mul_f32 v[76:77], v[76:77], v[172:173] op_sel:[0,1] op_sel_hi:[1,1]
    v_pk_mul_f32 v[78:79], v[78:79], v[172:173] op_sel:[0,1] op_sel_hi:[1,1]
    v_pk_mul_f32 v[80:81], v[80:81], v[174:175] op_sel:[0,1] op_sel_hi:[1,1]
    v_pk_mul_f32 v[82:83], v[82:83], v[174:175] op_sel:[0,1] op_sel_hi:[1,1]
    v_pk_mul_f32 v[84:85], v[84:85], v[176:177] op_sel:[0,1] op_sel_hi:[1,1]
    v_pk_mul_f32 v[86:87], v[86:87], v[176:177] op_sel:[0,1] op_sel_hi:[1,1]
    v_pk_mul_f32 v[88:89], v[88:89], v[168:169] op_sel:[0,1] op_sel_hi:[1,1]
    v_pk_mul_f32 v[90:91], v[90:91], v[168:169] op_sel:[0,1] op_sel_hi:[1,1]
    v_pk_mul_f32 v[92:93], v[92:93], v[170:171] op_sel:[0,1] op_sel_hi:[1,1]
    v_pk_mul_f32 v[94:95], v[94:95], v[170:171] op_sel:[0,1] op_sel_hi:[1,1]
    v_pk_mul_f32 v[96:97], v[96:97], v[172:173] op_sel:[0,1] op_sel_hi:[1,1]
    v_pk_mul_f32 v[98:99], v[98:99], v[172:173] op_sel:[0,1] op_sel_hi:[1,1]
    v_pk_mul_f32 v[100:101], v[100:101], v[174:175] op_sel:[0,1] op_sel_hi:[1,1]
    v_pk_mul_f32 v[102:103], v[102:103], v[174:175] op_sel:[0,1] op_sel_hi:[1,1]
    v_pk_mul_f32 v[104:105], v[104:105], v[176:177] op_sel:[0,1] op_sel_hi:[1,1]
    v_pk_mul_f32 v[106:107], v[106:107], v[176:177] op_sel:[0,1] op_sel_hi:[1,1]
    v_pk_mul_f32 v[108:109], v[108:109], v[168:169] op_sel:[0,1] op_sel_hi:[1,1]
    v_pk_mul_f32 v[110:111], v[110:111], v[168:169] op_sel:[0,1] op_sel_hi:[1,1]
    v_pk_mul_f32 v[112:113], v[112:113], v[170:171] op_sel:[0,1] op_sel_hi:[1,1]
    v_pk_mul_f32 v[114:115], v[114:115], v[170:171] op_sel:[0,1] op_sel_hi:[1,1]
    v_pk_mul_f32 v[116:117], v[116:117], v[172:173] op_sel:[0,1] op_sel_hi:[1,1]
    v_pk_mul_f32 v[118:119], v[118:119], v[172:173] op_sel:[0,1] op_sel_hi:[1,1]
    v_pk_mul_f32 v[120:121], v[120:121], v[174:175] op_sel:[0,1] op_sel_hi:[1,1]
    v_pk_mul_f32 v[122:123], v[122:123], v[174:175] op_sel:[0,1] op_sel_hi:[1,1]
    v_pk_mul_f32 v[124:125], v[124:125], v[176:177] op_sel:[0,1] op_sel_hi:[1,1]
    v_pk_mul_f32 v[126:127], v[126:127], v[176:177] op_sel:[0,1] op_sel_hi:[1,1]
    s_waitcnt lgkmcnt(0)
    s_barrier
    ds_read_b128 v[144:147], v212
    ds_read_b128 v[148:151], v213
    ds_read_b128 v[152:155], v214
    ds_read_b128 v[156:159], v215
    ds_read_b128 v[160:163], v216
    ds_read_b128 v[164:167], v217
    s_mov_b32 s28, s10
    s_mov_b32 s29, s11
    s_mov_b32 s30, 8912896
    s_mov_b32 s31, 0x00020000
    s_mov_b32 s60, 0xbfb8aa3b
    s_mov_b32 s61, 0xbfb8aa3b
    s_mov_b32 s62, 1.0
    s_mov_b32 s63, 1.0
    v_lshlrev_b32 v2, 4, v0
    s_mul_i32 s36, s15, 10
    s_mul_i32 s37, s20, 5
    s_add_u32 s36, s36, s37
    s_mul_i32 s36, s36, 68
    s_mul_i32 s37, s14, 6
    s_add_u32 s36, s36, s37
    s_add_u32 s36, s36, 20
    s_lshl_b32 s36, s36, 10
    s_waitcnt lgkmcnt(4)
    v_pk_fma_f32 v[8:9], v[144:145], v[168:169], v[8:9] op_sel:[0,0,0] op_sel_hi:[1,0,1]
    v_pk_fma_f32 v[10:11], v[146:147], v[168:169], v[10:11] op_sel:[0,0,0] op_sel_hi:[1,0,1]
    v_pk_fma_f32 v[28:29], v[148:149], v[168:169], v[28:29] op_sel:[0,0,0] op_sel_hi:[1,0,1]
    v_pk_fma_f32 v[30:31], v[150:151], v[168:169], v[30:31] op_sel:[0,0,0] op_sel_hi:[1,0,1]
    v_pk_mul_f32 v[180:181], v[8:9], s[60:61]
    v_pk_mul_f32 v[182:183], v[10:11], s[60:61]
    v_pk_mul_f32 v[184:185], v[28:29], s[60:61]
    v_pk_mul_f32 v[186:187], v[30:31], s[60:61]
    v_exp_f32 v180, v180
    v_exp_f32 v181, v181
    v_exp_f32 v182, v182
    v_exp_f32 v183, v183
    v_exp_f32 v184, v184
    v_exp_f32 v185, v185
    v_exp_f32 v186, v186
    v_exp_f32 v187, v187
    v_pk_add_f32 v[180:181], v[180:181], s[62:63]
    v_pk_add_f32 v[182:183], v[182:183], s[62:63]
    v_pk_add_f32 v[184:185], v[184:185], s[62:63]
    v_pk_add_f32 v[186:187], v[186:187], s[62:63]
    v_rcp_f32 v180, v180
    v_rcp_f32 v181, v181
    v_rcp_f32 v182, v182
    v_rcp_f32 v183, v183
    v_rcp_f32 v184, v184
    v_rcp_f32 v185, v185
    v_rcp_f32 v186, v186
    v_rcp_f32 v187, v187
    s_lshl_b32 s37, s52, 8
    s_add_u32 s37, s37, s36
    s_add_u32 s37, s37, 0
    v_pk_mul_f32 v[180:181], v[8:9], v[180:181]
    v_pk_mul_f32 v[182:183], v[10:11], v[182:183]
    v_pk_mul_f32 v[184:185], v[28:29], v[184:185]
    v_pk_mul_f32 v[186:187], v[30:31], v[186:187]
    v_cvt_pk_bf16_f32 v188, v180, v181
    v_cvt_pk_bf16_f32 v189, v182, v183
    v_cvt_pk_bf16_f32 v190, v184, v185
    v_cvt_pk_bf16_f32 v191, v186, v187
    buffer_store_dwordx4 v[188:191], v2, s[28:31], s37 offen sc1
    v_pk_fma_f32 v[12:13], v[144:145], v[170:171], v[12:13] op_sel:[0,0,0] op_sel_hi:[1,0,1]
    v_pk_fma_f32 v[14:15], v[146:147], v[170:171], v[14:15] op_sel:[0,0,0] op_sel_hi:[1,0,1]
    v_pk_fma_f32 v[32:33], v[148:149], v[170:171], v[32:33] op_sel:[0,0,0] op_sel_hi:[1,0,1]
    v_pk_fma_f32 v[34:35], v[150:151], v[170:171], v[34:35] op_sel:[0,0,0] op_sel_hi:[1,0,1]
    v_pk_mul_f32 v[192:193], v[12:13], s[60:61]
    v_pk_mul_f32 v[194:195], v[14:15], s[60:61]
    v_pk_mul_f32 v[196:197], v[32:33], s[60:61]
    v_pk_mul_f32 v[198:199], v[34:35], s[60:61]
    v_exp_f32 v192, v192
    v_exp_f32 v193, v193
    v_exp_f32 v194, v194
    v_exp_f32 v195, v195
    v_exp_f32 v196, v196
    v_exp_f32 v197, v197
    v_exp_f32 v198, v198
    v_exp_f32 v199, v199
    v_pk_add_f32 v[192:193], v[192:193], s[62:63]
    v_pk_add_f32 v[194:195], v[194:195], s[62:63]
    v_pk_add_f32 v[196:197], v[196:197], s[62:63]
    v_pk_add_f32 v[198:199], v[198:199], s[62:63]
    v_rcp_f32 v192, v192
    v_rcp_f32 v193, v193
    v_rcp_f32 v194, v194
    v_rcp_f32 v195, v195
    v_rcp_f32 v196, v196
    v_rcp_f32 v197, v197
    v_rcp_f32 v198, v198
    v_rcp_f32 v199, v199
    s_lshl_b32 s37, s52, 8
    s_add_u32 s37, s37, s36
    s_add_u32 s37, s37, 69632
    v_pk_mul_f32 v[192:193], v[12:13], v[192:193]
    v_pk_mul_f32 v[194:195], v[14:15], v[194:195]
    v_pk_mul_f32 v[196:197], v[32:33], v[196:197]
    v_pk_mul_f32 v[198:199], v[34:35], v[198:199]
    v_cvt_pk_bf16_f32 v200, v192, v193
    v_cvt_pk_bf16_f32 v201, v194, v195
    v_cvt_pk_bf16_f32 v202, v196, v197
    v_cvt_pk_bf16_f32 v203, v198, v199
    buffer_store_dwordx4 v[200:203], v2, s[28:31], s37 offen sc1
    v_pk_fma_f32 v[16:17], v[144:145], v[172:173], v[16:17] op_sel:[0,0,0] op_sel_hi:[1,0,1]
    v_pk_fma_f32 v[18:19], v[146:147], v[172:173], v[18:19] op_sel:[0,0,0] op_sel_hi:[1,0,1]
    v_pk_fma_f32 v[36:37], v[148:149], v[172:173], v[36:37] op_sel:[0,0,0] op_sel_hi:[1,0,1]
    v_pk_fma_f32 v[38:39], v[150:151], v[172:173], v[38:39] op_sel:[0,0,0] op_sel_hi:[1,0,1]
    v_pk_mul_f32 v[180:181], v[16:17], s[60:61]
    v_pk_mul_f32 v[182:183], v[18:19], s[60:61]
    v_pk_mul_f32 v[184:185], v[36:37], s[60:61]
    v_pk_mul_f32 v[186:187], v[38:39], s[60:61]
    v_exp_f32 v180, v180
    v_exp_f32 v181, v181
    v_exp_f32 v182, v182
    v_exp_f32 v183, v183
    v_exp_f32 v184, v184
    v_exp_f32 v185, v185
    v_exp_f32 v186, v186
    v_exp_f32 v187, v187
    v_pk_add_f32 v[180:181], v[180:181], s[62:63]
    v_pk_add_f32 v[182:183], v[182:183], s[62:63]
    v_pk_add_f32 v[184:185], v[184:185], s[62:63]
    v_pk_add_f32 v[186:187], v[186:187], s[62:63]
    v_rcp_f32 v180, v180
    v_rcp_f32 v181, v181
    v_rcp_f32 v182, v182
    v_rcp_f32 v183, v183
    v_rcp_f32 v184, v184
    v_rcp_f32 v185, v185
    v_rcp_f32 v186, v186
    v_rcp_f32 v187, v187
    s_lshl_b32 s37, s52, 8
    s_add_u32 s37, s37, s36
    s_add_u32 s37, s37, 139264
    v_pk_mul_f32 v[180:181], v[16:17], v[180:181]
    v_pk_mul_f32 v[182:183], v[18:19], v[182:183]
    v_pk_mul_f32 v[184:185], v[36:37], v[184:185]
    v_pk_mul_f32 v[186:187], v[38:39], v[186:187]
    v_cvt_pk_bf16_f32 v188, v180, v181
    v_cvt_pk_bf16_f32 v189, v182, v183
    v_cvt_pk_bf16_f32 v190, v184, v185
    v_cvt_pk_bf16_f32 v191, v186, v187
    buffer_store_dwordx4 v[188:191], v2, s[28:31], s37 offen sc1
    v_pk_fma_f32 v[20:21], v[144:145], v[174:175], v[20:21] op_sel:[0,0,0] op_sel_hi:[1,0,1]
    v_pk_fma_f32 v[22:23], v[146:147], v[174:175], v[22:23] op_sel:[0,0,0] op_sel_hi:[1,0,1]
    v_pk_fma_f32 v[40:41], v[148:149], v[174:175], v[40:41] op_sel:[0,0,0] op_sel_hi:[1,0,1]
    v_pk_fma_f32 v[42:43], v[150:151], v[174:175], v[42:43] op_sel:[0,0,0] op_sel_hi:[1,0,1]
    v_pk_mul_f32 v[192:193], v[20:21], s[60:61]
    v_pk_mul_f32 v[194:195], v[22:23], s[60:61]
    v_pk_mul_f32 v[196:197], v[40:41], s[60:61]
    v_pk_mul_f32 v[198:199], v[42:43], s[60:61]
    v_exp_f32 v192, v192
    v_exp_f32 v193, v193
    v_exp_f32 v194, v194
    v_exp_f32 v195, v195
    v_exp_f32 v196, v196
    v_exp_f32 v197, v197
    v_exp_f32 v198, v198
    v_exp_f32 v199, v199
    v_pk_add_f32 v[192:193], v[192:193], s[62:63]
    v_pk_add_f32 v[194:195], v[194:195], s[62:63]
    v_pk_add_f32 v[196:197], v[196:197], s[62:63]
    v_pk_add_f32 v[198:199], v[198:199], s[62:63]
    v_rcp_f32 v192, v192
    v_rcp_f32 v193, v193
    v_rcp_f32 v194, v194
    v_rcp_f32 v195, v195
    v_rcp_f32 v196, v196
    v_rcp_f32 v197, v197
    v_rcp_f32 v198, v198
    v_rcp_f32 v199, v199
    s_lshl_b32 s37, s52, 8
    s_add_u32 s37, s37, s36
    s_add_u32 s37, s37, 208896
    v_pk_mul_f32 v[192:193], v[20:21], v[192:193]
    v_pk_mul_f32 v[194:195], v[22:23], v[194:195]
    v_pk_mul_f32 v[196:197], v[40:41], v[196:197]
    v_pk_mul_f32 v[198:199], v[42:43], v[198:199]
    v_cvt_pk_bf16_f32 v200, v192, v193
    v_cvt_pk_bf16_f32 v201, v194, v195
    v_cvt_pk_bf16_f32 v202, v196, v197
    v_cvt_pk_bf16_f32 v203, v198, v199
    buffer_store_dwordx4 v[200:203], v2, s[28:31], s37 offen sc1
    v_pk_fma_f32 v[24:25], v[144:145], v[176:177], v[24:25] op_sel:[0,0,0] op_sel_hi:[1,0,1]
    v_pk_fma_f32 v[26:27], v[146:147], v[176:177], v[26:27] op_sel:[0,0,0] op_sel_hi:[1,0,1]
    v_pk_fma_f32 v[44:45], v[148:149], v[176:177], v[44:45] op_sel:[0,0,0] op_sel_hi:[1,0,1]
    v_pk_fma_f32 v[46:47], v[150:151], v[176:177], v[46:47] op_sel:[0,0,0] op_sel_hi:[1,0,1]
    v_pk_mul_f32 v[180:181], v[24:25], s[60:61]
    v_pk_mul_f32 v[182:183], v[26:27], s[60:61]
    v_pk_mul_f32 v[184:185], v[44:45], s[60:61]
    v_pk_mul_f32 v[186:187], v[46:47], s[60:61]
    v_exp_f32 v180, v180
    v_exp_f32 v181, v181
    v_exp_f32 v182, v182
    v_exp_f32 v183, v183
    v_exp_f32 v184, v184
    v_exp_f32 v185, v185
    v_exp_f32 v186, v186
    v_exp_f32 v187, v187
    v_pk_add_f32 v[180:181], v[180:181], s[62:63]
    v_pk_add_f32 v[182:183], v[182:183], s[62:63]
    v_pk_add_f32 v[184:185], v[184:185], s[62:63]
    v_pk_add_f32 v[186:187], v[186:187], s[62:63]
    v_rcp_f32 v180, v180
    v_rcp_f32 v181, v181
    v_rcp_f32 v182, v182
    v_rcp_f32 v183, v183
    v_rcp_f32 v184, v184
    v_rcp_f32 v185, v185
    v_rcp_f32 v186, v186
    v_rcp_f32 v187, v187
    s_lshl_b32 s37, s52, 8
    s_add_u32 s37, s37, s36
    s_add_u32 s37, s37, 278528
    v_pk_mul_f32 v[180:181], v[24:25], v[180:181]
    v_pk_mul_f32 v[182:183], v[26:27], v[182:183]
    v_pk_mul_f32 v[184:185], v[44:45], v[184:185]
    v_pk_mul_f32 v[186:187], v[46:47], v[186:187]
    v_cvt_pk_bf16_f32 v188, v180, v181
    v_cvt_pk_bf16_f32 v189, v182, v183
    v_cvt_pk_bf16_f32 v190, v184, v185
    v_cvt_pk_bf16_f32 v191, v186, v187
    buffer_store_dwordx4 v[188:191], v2, s[28:31], s37 offen sc1
    s_waitcnt lgkmcnt(2)
    v_pk_fma_f32 v[48:49], v[152:153], v[168:169], v[48:49] op_sel:[0,0,0] op_sel_hi:[1,0,1]
    v_pk_fma_f32 v[50:51], v[154:155], v[168:169], v[50:51] op_sel:[0,0,0] op_sel_hi:[1,0,1]
    v_pk_fma_f32 v[68:69], v[156:157], v[168:169], v[68:69] op_sel:[0,0,0] op_sel_hi:[1,0,1]
    v_pk_fma_f32 v[70:71], v[158:159], v[168:169], v[70:71] op_sel:[0,0,0] op_sel_hi:[1,0,1]
    v_pk_mul_f32 v[192:193], v[48:49], s[60:61]
    v_pk_mul_f32 v[194:195], v[50:51], s[60:61]
    v_pk_mul_f32 v[196:197], v[68:69], s[60:61]
    v_pk_mul_f32 v[198:199], v[70:71], s[60:61]
    v_exp_f32 v192, v192
    v_exp_f32 v193, v193
    v_exp_f32 v194, v194
    v_exp_f32 v195, v195
    v_exp_f32 v196, v196
    v_exp_f32 v197, v197
    v_exp_f32 v198, v198
    v_exp_f32 v199, v199
    v_pk_add_f32 v[192:193], v[192:193], s[62:63]
    v_pk_add_f32 v[194:195], v[194:195], s[62:63]
    v_pk_add_f32 v[196:197], v[196:197], s[62:63]
    v_pk_add_f32 v[198:199], v[198:199], s[62:63]
    v_rcp_f32 v192, v192
    v_rcp_f32 v193, v193
    v_rcp_f32 v194, v194
    v_rcp_f32 v195, v195
    v_rcp_f32 v196, v196
    v_rcp_f32 v197, v197
    v_rcp_f32 v198, v198
    v_rcp_f32 v199, v199
    s_lshl_b32 s37, s54, 8
    s_add_u32 s37, s37, s36
    s_add_u32 s37, s37, 0
    v_pk_mul_f32 v[192:193], v[48:49], v[192:193]
    v_pk_mul_f32 v[194:195], v[50:51], v[194:195]
    v_pk_mul_f32 v[196:197], v[68:69], v[196:197]
    v_pk_mul_f32 v[198:199], v[70:71], v[198:199]
    v_cvt_pk_bf16_f32 v200, v192, v193
    v_cvt_pk_bf16_f32 v201, v194, v195
    v_cvt_pk_bf16_f32 v202, v196, v197
    v_cvt_pk_bf16_f32 v203, v198, v199
    buffer_store_dwordx4 v[200:203], v2, s[28:31], s37 offen sc1
    v_pk_fma_f32 v[52:53], v[152:153], v[170:171], v[52:53] op_sel:[0,0,0] op_sel_hi:[1,0,1]
    v_pk_fma_f32 v[54:55], v[154:155], v[170:171], v[54:55] op_sel:[0,0,0] op_sel_hi:[1,0,1]
    v_pk_fma_f32 v[72:73], v[156:157], v[170:171], v[72:73] op_sel:[0,0,0] op_sel_hi:[1,0,1]
    v_pk_fma_f32 v[74:75], v[158:159], v[170:171], v[74:75] op_sel:[0,0,0] op_sel_hi:[1,0,1]
    v_pk_mul_f32 v[180:181], v[52:53], s[60:61]
    v_pk_mul_f32 v[182:183], v[54:55], s[60:61]
    v_pk_mul_f32 v[184:185], v[72:73], s[60:61]
    v_pk_mul_f32 v[186:187], v[74:75], s[60:61]
    v_exp_f32 v180, v180
    v_exp_f32 v181, v181
    v_exp_f32 v182, v182
    v_exp_f32 v183, v183
    v_exp_f32 v184, v184
    v_exp_f32 v185, v185
    v_exp_f32 v186, v186
    v_exp_f32 v187, v187
    v_pk_add_f32 v[180:181], v[180:181], s[62:63]
    v_pk_add_f32 v[182:183], v[182:183], s[62:63]
    v_pk_add_f32 v[184:185], v[184:185], s[62:63]
    v_pk_add_f32 v[186:187], v[186:187], s[62:63]
    v_rcp_f32 v180, v180
    v_rcp_f32 v181, v181
    v_rcp_f32 v182, v182
    v_rcp_f32 v183, v183
    v_rcp_f32 v184, v184
    v_rcp_f32 v185, v185
    v_rcp_f32 v186, v186
    v_rcp_f32 v187, v187
    s_lshl_b32 s37, s54, 8
    s_add_u32 s37, s37, s36
    s_add_u32 s37, s37, 69632
    v_pk_mul_f32 v[180:181], v[52:53], v[180:181]
    v_pk_mul_f32 v[182:183], v[54:55], v[182:183]
    v_pk_mul_f32 v[184:185], v[72:73], v[184:185]
    v_pk_mul_f32 v[186:187], v[74:75], v[186:187]
    v_cvt_pk_bf16_f32 v188, v180, v181
    v_cvt_pk_bf16_f32 v189, v182, v183
    v_cvt_pk_bf16_f32 v190, v184, v185
    v_cvt_pk_bf16_f32 v191, v186, v187
    buffer_store_dwordx4 v[188:191], v2, s[28:31], s37 offen sc1
    v_pk_fma_f32 v[56:57], v[152:153], v[172:173], v[56:57] op_sel:[0,0,0] op_sel_hi:[1,0,1]
    v_pk_fma_f32 v[58:59], v[154:155], v[172:173], v[58:59] op_sel:[0,0,0] op_sel_hi:[1,0,1]
    v_pk_fma_f32 v[76:77], v[156:157], v[172:173], v[76:77] op_sel:[0,0,0] op_sel_hi:[1,0,1]
    v_pk_fma_f32 v[78:79], v[158:159], v[172:173], v[78:79] op_sel:[0,0,0] op_sel_hi:[1,0,1]
    v_pk_mul_f32 v[192:193], v[56:57], s[60:61]
    v_pk_mul_f32 v[194:195], v[58:59], s[60:61]
    v_pk_mul_f32 v[196:197], v[76:77], s[60:61]
    v_pk_mul_f32 v[198:199], v[78:79], s[60:61]
    v_exp_f32 v192, v192
    v_exp_f32 v193, v193
    v_exp_f32 v194, v194
    v_exp_f32 v195, v195
    v_exp_f32 v196, v196
    v_exp_f32 v197, v197
    v_exp_f32 v198, v198
    v_exp_f32 v199, v199
    v_pk_add_f32 v[192:193], v[192:193], s[62:63]
    v_pk_add_f32 v[194:195], v[194:195], s[62:63]
    v_pk_add_f32 v[196:197], v[196:197], s[62:63]
    v_pk_add_f32 v[198:199], v[198:199], s[62:63]
    v_rcp_f32 v192, v192
    v_rcp_f32 v193, v193
    v_rcp_f32 v194, v194
    v_rcp_f32 v195, v195
    v_rcp_f32 v196, v196
    v_rcp_f32 v197, v197
    v_rcp_f32 v198, v198
    v_rcp_f32 v199, v199
    s_lshl_b32 s37, s54, 8
    s_add_u32 s37, s37, s36
    s_add_u32 s37, s37, 139264
    v_pk_mul_f32 v[192:193], v[56:57], v[192:193]
    v_pk_mul_f32 v[194:195], v[58:59], v[194:195]
    v_pk_mul_f32 v[196:197], v[76:77], v[196:197]
    v_pk_mul_f32 v[198:199], v[78:79], v[198:199]
    v_cvt_pk_bf16_f32 v200, v192, v193
    v_cvt_pk_bf16_f32 v201, v194, v195
    v_cvt_pk_bf16_f32 v202, v196, v197
    v_cvt_pk_bf16_f32 v203, v198, v199
    buffer_store_dwordx4 v[200:203], v2, s[28:31], s37 offen sc1
    v_pk_fma_f32 v[60:61], v[152:153], v[174:175], v[60:61] op_sel:[0,0,0] op_sel_hi:[1,0,1]
    v_pk_fma_f32 v[62:63], v[154:155], v[174:175], v[62:63] op_sel:[0,0,0] op_sel_hi:[1,0,1]
    v_pk_fma_f32 v[80:81], v[156:157], v[174:175], v[80:81] op_sel:[0,0,0] op_sel_hi:[1,0,1]
    v_pk_fma_f32 v[82:83], v[158:159], v[174:175], v[82:83] op_sel:[0,0,0] op_sel_hi:[1,0,1]
    v_pk_mul_f32 v[180:181], v[60:61], s[60:61]
    v_pk_mul_f32 v[182:183], v[62:63], s[60:61]
    v_pk_mul_f32 v[184:185], v[80:81], s[60:61]
    v_pk_mul_f32 v[186:187], v[82:83], s[60:61]
    v_exp_f32 v180, v180
    v_exp_f32 v181, v181
    v_exp_f32 v182, v182
    v_exp_f32 v183, v183
    v_exp_f32 v184, v184
    v_exp_f32 v185, v185
    v_exp_f32 v186, v186
    v_exp_f32 v187, v187
    v_pk_add_f32 v[180:181], v[180:181], s[62:63]
    v_pk_add_f32 v[182:183], v[182:183], s[62:63]
    v_pk_add_f32 v[184:185], v[184:185], s[62:63]
    v_pk_add_f32 v[186:187], v[186:187], s[62:63]
    v_rcp_f32 v180, v180
    v_rcp_f32 v181, v181
    v_rcp_f32 v182, v182
    v_rcp_f32 v183, v183
    v_rcp_f32 v184, v184
    v_rcp_f32 v185, v185
    v_rcp_f32 v186, v186
    v_rcp_f32 v187, v187
    s_lshl_b32 s37, s54, 8
    s_add_u32 s37, s37, s36
    s_add_u32 s37, s37, 208896
    v_pk_mul_f32 v[180:181], v[60:61], v[180:181]
    v_pk_mul_f32 v[182:183], v[62:63], v[182:183]
    v_pk_mul_f32 v[184:185], v[80:81], v[184:185]
    v_pk_mul_f32 v[186:187], v[82:83], v[186:187]
    v_cvt_pk_bf16_f32 v188, v180, v181
    v_cvt_pk_bf16_f32 v189, v182, v183
    v_cvt_pk_bf16_f32 v190, v184, v185
    v_cvt_pk_bf16_f32 v191, v186, v187
    buffer_store_dwordx4 v[188:191], v2, s[28:31], s37 offen sc1
    v_pk_fma_f32 v[64:65], v[152:153], v[176:177], v[64:65] op_sel:[0,0,0] op_sel_hi:[1,0,1]
    v_pk_fma_f32 v[66:67], v[154:155], v[176:177], v[66:67] op_sel:[0,0,0] op_sel_hi:[1,0,1]
    v_pk_fma_f32 v[84:85], v[156:157], v[176:177], v[84:85] op_sel:[0,0,0] op_sel_hi:[1,0,1]
    v_pk_fma_f32 v[86:87], v[158:159], v[176:177], v[86:87] op_sel:[0,0,0] op_sel_hi:[1,0,1]
    v_pk_mul_f32 v[192:193], v[64:65], s[60:61]
    v_pk_mul_f32 v[194:195], v[66:67], s[60:61]
    v_pk_mul_f32 v[196:197], v[84:85], s[60:61]
    v_pk_mul_f32 v[198:199], v[86:87], s[60:61]
    v_exp_f32 v192, v192
    v_exp_f32 v193, v193
    v_exp_f32 v194, v194
    v_exp_f32 v195, v195
    v_exp_f32 v196, v196
    v_exp_f32 v197, v197
    v_exp_f32 v198, v198
    v_exp_f32 v199, v199
    v_pk_add_f32 v[192:193], v[192:193], s[62:63]
    v_pk_add_f32 v[194:195], v[194:195], s[62:63]
    v_pk_add_f32 v[196:197], v[196:197], s[62:63]
    v_pk_add_f32 v[198:199], v[198:199], s[62:63]
    v_rcp_f32 v192, v192
    v_rcp_f32 v193, v193
    v_rcp_f32 v194, v194
    v_rcp_f32 v195, v195
    v_rcp_f32 v196, v196
    v_rcp_f32 v197, v197
    v_rcp_f32 v198, v198
    v_rcp_f32 v199, v199
    s_lshl_b32 s37, s54, 8
    s_add_u32 s37, s37, s36
    s_add_u32 s37, s37, 278528
    v_pk_mul_f32 v[192:193], v[64:65], v[192:193]
    v_pk_mul_f32 v[194:195], v[66:67], v[194:195]
    v_pk_mul_f32 v[196:197], v[84:85], v[196:197]
    v_pk_mul_f32 v[198:199], v[86:87], v[198:199]
    v_cvt_pk_bf16_f32 v200, v192, v193
    v_cvt_pk_bf16_f32 v201, v194, v195
    v_cvt_pk_bf16_f32 v202, v196, v197
    v_cvt_pk_bf16_f32 v203, v198, v199
    buffer_store_dwordx4 v[200:203], v2, s[28:31], s37 offen sc1
    s_waitcnt lgkmcnt(0)
    v_pk_fma_f32 v[88:89], v[160:161], v[168:169], v[88:89] op_sel:[0,0,0] op_sel_hi:[1,0,1]
    v_pk_fma_f32 v[90:91], v[162:163], v[168:169], v[90:91] op_sel:[0,0,0] op_sel_hi:[1,0,1]
    v_pk_fma_f32 v[108:109], v[164:165], v[168:169], v[108:109] op_sel:[0,0,0] op_sel_hi:[1,0,1]
    v_pk_fma_f32 v[110:111], v[166:167], v[168:169], v[110:111] op_sel:[0,0,0] op_sel_hi:[1,0,1]
    v_pk_mul_f32 v[180:181], v[88:89], s[60:61]
    v_pk_mul_f32 v[182:183], v[90:91], s[60:61]
    v_pk_mul_f32 v[184:185], v[108:109], s[60:61]
    v_pk_mul_f32 v[186:187], v[110:111], s[60:61]
    v_exp_f32 v180, v180
    v_exp_f32 v181, v181
    v_exp_f32 v182, v182
    v_exp_f32 v183, v183
    v_exp_f32 v184, v184
    v_exp_f32 v185, v185
    v_exp_f32 v186, v186
    v_exp_f32 v187, v187
    v_pk_add_f32 v[180:181], v[180:181], s[62:63]
    v_pk_add_f32 v[182:183], v[182:183], s[62:63]
    v_pk_add_f32 v[184:185], v[184:185], s[62:63]
    v_pk_add_f32 v[186:187], v[186:187], s[62:63]
    v_rcp_f32 v180, v180
    v_rcp_f32 v181, v181
    v_rcp_f32 v182, v182
    v_rcp_f32 v183, v183
    v_rcp_f32 v184, v184
    v_rcp_f32 v185, v185
    v_rcp_f32 v186, v186
    v_rcp_f32 v187, v187
    s_lshl_b32 s37, s56, 8
    s_add_u32 s37, s37, s36
    s_add_u32 s37, s37, 0
    v_pk_mul_f32 v[180:181], v[88:89], v[180:181]
    v_pk_mul_f32 v[182:183], v[90:91], v[182:183]
    v_pk_mul_f32 v[184:185], v[108:109], v[184:185]
    v_pk_mul_f32 v[186:187], v[110:111], v[186:187]
    v_cvt_pk_bf16_f32 v188, v180, v181
    v_cvt_pk_bf16_f32 v189, v182, v183
    v_cvt_pk_bf16_f32 v190, v184, v185
    v_cvt_pk_bf16_f32 v191, v186, v187
    buffer_store_dwordx4 v[188:191], v2, s[28:31], s37 offen sc1
    v_pk_fma_f32 v[92:93], v[160:161], v[170:171], v[92:93] op_sel:[0,0,0] op_sel_hi:[1,0,1]
    v_pk_fma_f32 v[94:95], v[162:163], v[170:171], v[94:95] op_sel:[0,0,0] op_sel_hi:[1,0,1]
    v_pk_fma_f32 v[112:113], v[164:165], v[170:171], v[112:113] op_sel:[0,0,0] op_sel_hi:[1,0,1]
    v_pk_fma_f32 v[114:115], v[166:167], v[170:171], v[114:115] op_sel:[0,0,0] op_sel_hi:[1,0,1]
    v_pk_mul_f32 v[192:193], v[92:93], s[60:61]
    v_pk_mul_f32 v[194:195], v[94:95], s[60:61]
    v_pk_mul_f32 v[196:197], v[112:113], s[60:61]
    v_pk_mul_f32 v[198:199], v[114:115], s[60:61]
    v_exp_f32 v192, v192
    v_exp_f32 v193, v193
    v_exp_f32 v194, v194
    v_exp_f32 v195, v195
    v_exp_f32 v196, v196
    v_exp_f32 v197, v197
    v_exp_f32 v198, v198
    v_exp_f32 v199, v199
    v_pk_add_f32 v[192:193], v[192:193], s[62:63]
    v_pk_add_f32 v[194:195], v[194:195], s[62:63]
    v_pk_add_f32 v[196:197], v[196:197], s[62:63]
    v_pk_add_f32 v[198:199], v[198:199], s[62:63]
    v_rcp_f32 v192, v192
    v_rcp_f32 v193, v193
    v_rcp_f32 v194, v194
    v_rcp_f32 v195, v195
    v_rcp_f32 v196, v196
    v_rcp_f32 v197, v197
    v_rcp_f32 v198, v198
    v_rcp_f32 v199, v199
    s_lshl_b32 s37, s56, 8
    s_add_u32 s37, s37, s36
    s_add_u32 s37, s37, 69632
    v_pk_mul_f32 v[192:193], v[92:93], v[192:193]
    v_pk_mul_f32 v[194:195], v[94:95], v[194:195]
    v_pk_mul_f32 v[196:197], v[112:113], v[196:197]
    v_pk_mul_f32 v[198:199], v[114:115], v[198:199]
    v_cvt_pk_bf16_f32 v200, v192, v193
    v_cvt_pk_bf16_f32 v201, v194, v195
    v_cvt_pk_bf16_f32 v202, v196, v197
    v_cvt_pk_bf16_f32 v203, v198, v199
    buffer_store_dwordx4 v[200:203], v2, s[28:31], s37 offen sc1
    v_pk_fma_f32 v[96:97], v[160:161], v[172:173], v[96:97] op_sel:[0,0,0] op_sel_hi:[1,0,1]
    v_pk_fma_f32 v[98:99], v[162:163], v[172:173], v[98:99] op_sel:[0,0,0] op_sel_hi:[1,0,1]
    v_pk_fma_f32 v[116:117], v[164:165], v[172:173], v[116:117] op_sel:[0,0,0] op_sel_hi:[1,0,1]
    v_pk_fma_f32 v[118:119], v[166:167], v[172:173], v[118:119] op_sel:[0,0,0] op_sel_hi:[1,0,1]
    v_pk_mul_f32 v[180:181], v[96:97], s[60:61]
    v_pk_mul_f32 v[182:183], v[98:99], s[60:61]
    v_pk_mul_f32 v[184:185], v[116:117], s[60:61]
    v_pk_mul_f32 v[186:187], v[118:119], s[60:61]
    v_exp_f32 v180, v180
    v_exp_f32 v181, v181
    v_exp_f32 v182, v182
    v_exp_f32 v183, v183
    v_exp_f32 v184, v184
    v_exp_f32 v185, v185
    v_exp_f32 v186, v186
    v_exp_f32 v187, v187
    v_pk_add_f32 v[180:181], v[180:181], s[62:63]
    v_pk_add_f32 v[182:183], v[182:183], s[62:63]
    v_pk_add_f32 v[184:185], v[184:185], s[62:63]
    v_pk_add_f32 v[186:187], v[186:187], s[62:63]
    v_rcp_f32 v180, v180
    v_rcp_f32 v181, v181
    v_rcp_f32 v182, v182
    v_rcp_f32 v183, v183
    v_rcp_f32 v184, v184
    v_rcp_f32 v185, v185
    v_rcp_f32 v186, v186
    v_rcp_f32 v187, v187
    s_lshl_b32 s37, s56, 8
    s_add_u32 s37, s37, s36
    s_add_u32 s37, s37, 139264
    v_pk_mul_f32 v[180:181], v[96:97], v[180:181]
    v_pk_mul_f32 v[182:183], v[98:99], v[182:183]
    v_pk_mul_f32 v[184:185], v[116:117], v[184:185]
    v_pk_mul_f32 v[186:187], v[118:119], v[186:187]
    v_cvt_pk_bf16_f32 v188, v180, v181
    v_cvt_pk_bf16_f32 v189, v182, v183
    v_cvt_pk_bf16_f32 v190, v184, v185
    v_cvt_pk_bf16_f32 v191, v186, v187
    buffer_store_dwordx4 v[188:191], v2, s[28:31], s37 offen sc1
    v_pk_fma_f32 v[100:101], v[160:161], v[174:175], v[100:101] op_sel:[0,0,0] op_sel_hi:[1,0,1]
    v_pk_fma_f32 v[102:103], v[162:163], v[174:175], v[102:103] op_sel:[0,0,0] op_sel_hi:[1,0,1]
    v_pk_fma_f32 v[120:121], v[164:165], v[174:175], v[120:121] op_sel:[0,0,0] op_sel_hi:[1,0,1]
    v_pk_fma_f32 v[122:123], v[166:167], v[174:175], v[122:123] op_sel:[0,0,0] op_sel_hi:[1,0,1]
    v_pk_mul_f32 v[192:193], v[100:101], s[60:61]
    v_pk_mul_f32 v[194:195], v[102:103], s[60:61]
    v_pk_mul_f32 v[196:197], v[120:121], s[60:61]
    v_pk_mul_f32 v[198:199], v[122:123], s[60:61]
    v_exp_f32 v192, v192
    v_exp_f32 v193, v193
    v_exp_f32 v194, v194
    v_exp_f32 v195, v195
    v_exp_f32 v196, v196
    v_exp_f32 v197, v197
    v_exp_f32 v198, v198
    v_exp_f32 v199, v199
    v_pk_add_f32 v[192:193], v[192:193], s[62:63]
    v_pk_add_f32 v[194:195], v[194:195], s[62:63]
    v_pk_add_f32 v[196:197], v[196:197], s[62:63]
    v_pk_add_f32 v[198:199], v[198:199], s[62:63]
    v_rcp_f32 v192, v192
    v_rcp_f32 v193, v193
    v_rcp_f32 v194, v194
    v_rcp_f32 v195, v195
    v_rcp_f32 v196, v196
    v_rcp_f32 v197, v197
    v_rcp_f32 v198, v198
    v_rcp_f32 v199, v199
    s_lshl_b32 s37, s56, 8
    s_add_u32 s37, s37, s36
    s_add_u32 s37, s37, 208896
    v_pk_mul_f32 v[192:193], v[100:101], v[192:193]
    v_pk_mul_f32 v[194:195], v[102:103], v[194:195]
    v_pk_mul_f32 v[196:197], v[120:121], v[196:197]
    v_pk_mul_f32 v[198:199], v[122:123], v[198:199]
    v_cvt_pk_bf16_f32 v200, v192, v193
    v_cvt_pk_bf16_f32 v201, v194, v195
    v_cvt_pk_bf16_f32 v202, v196, v197
    v_cvt_pk_bf16_f32 v203, v198, v199
    buffer_store_dwordx4 v[200:203], v2, s[28:31], s37 offen sc1
    v_pk_fma_f32 v[104:105], v[160:161], v[176:177], v[104:105] op_sel:[0,0,0] op_sel_hi:[1,0,1]
    v_pk_fma_f32 v[106:107], v[162:163], v[176:177], v[106:107] op_sel:[0,0,0] op_sel_hi:[1,0,1]
    v_pk_fma_f32 v[124:125], v[164:165], v[176:177], v[124:125] op_sel:[0,0,0] op_sel_hi:[1,0,1]
    v_pk_fma_f32 v[126:127], v[166:167], v[176:177], v[126:127] op_sel:[0,0,0] op_sel_hi:[1,0,1]
    v_pk_mul_f32 v[180:181], v[104:105], s[60:61]
    v_pk_mul_f32 v[182:183], v[106:107], s[60:61]
    v_pk_mul_f32 v[184:185], v[124:125], s[60:61]
    v_pk_mul_f32 v[186:187], v[126:127], s[60:61]
    v_exp_f32 v180, v180
    v_exp_f32 v181, v181
    v_exp_f32 v182, v182
    v_exp_f32 v183, v183
    v_exp_f32 v184, v184
    v_exp_f32 v185, v185
    v_exp_f32 v186, v186
    v_exp_f32 v187, v187
    v_pk_add_f32 v[180:181], v[180:181], s[62:63]
    v_pk_add_f32 v[182:183], v[182:183], s[62:63]
    v_pk_add_f32 v[184:185], v[184:185], s[62:63]
    v_pk_add_f32 v[186:187], v[186:187], s[62:63]
    v_rcp_f32 v180, v180
    v_rcp_f32 v181, v181
    v_rcp_f32 v182, v182
    v_rcp_f32 v183, v183
    v_rcp_f32 v184, v184
    v_rcp_f32 v185, v185
    v_rcp_f32 v186, v186
    v_rcp_f32 v187, v187
    s_lshl_b32 s37, s56, 8
    s_add_u32 s37, s37, s36
    s_add_u32 s37, s37, 278528
    v_pk_mul_f32 v[180:181], v[104:105], v[180:181]
    v_pk_mul_f32 v[182:183], v[106:107], v[182:183]
    v_pk_mul_f32 v[184:185], v[124:125], v[184:185]
    v_pk_mul_f32 v[186:187], v[126:127], v[186:187]
    v_cvt_pk_bf16_f32 v188, v180, v181
    v_cvt_pk_bf16_f32 v189, v182, v183
    v_cvt_pk_bf16_f32 v190, v184, v185
    v_cvt_pk_bf16_f32 v191, v186, v187
    buffer_store_dwordx4 v[188:191], v2, s[28:31], s37 offen sc1
    s_branch fz_phase2
fz_f_loader:
    s_sub_u32 s3, s19, 4
    v_lshrrev_b32 v3, 3, v0
    v_and_b32 v4, 7, v0
    v_xor_b32 v4, v4, v3
    v_mul_u32_u24 v3, 1280, v3
    v_lshl_add_u32 v3, v4, 4, v3
    s_mul_i32 s36, s15, 160
    s_mul_i32 s37, s3, 40
    s_add_u32 s36, s36, s37
    s_mul_i32 s36, s36, 1280
    v_add_u32 v3, s36, v3
    v_add_u32 v16, 0, v3
    v_add_u32 v17, 9216, v3
    v_add_u32 v18, 18432, v3
    v_add_u32 v19, 27648, v3
    v_add_u32 v20, 40960, v3
    s_mul_i32 s37, s3, 49152
    s_mul_i32 s38, s14, 384
    s_add_u32 s37, s37, s38
    v_add_u32 v5, 0, v0
    v_mul_u32_u24 v6, 171, v5
    v_lshrrev_b32 v6, 12, v6
    v_mul_u32_u24 v7, 24, v6
    v_sub_u32 v7, v5, v7
    v_lshrrev_b32 v25, 1, v6
    v_and_b32 v25, 4, v25
    v_and_or_b32 v24, v6, 2, v25
    v_xor_b32 v7, v7, v24
    v_mul_u32_u24 v6, 3072, v6
    v_lshl_add_u32 v6, v7, 4, v6
    s_sub_u32 s38, s37, 0
    v_add_u32 v8, s38, v6
    v_add_u32 v5, 64, v0
    v_mul_u32_u24 v6, 171, v5
    v_lshrrev_b32 v6, 12, v6
    v_mul_u32_u24 v7, 24, v6
    v_sub_u32 v7, v5, v7
    v_lshrrev_b32 v25, 1, v6
    v_and_b32 v25, 4, v25
    v_and_or_b32 v24, v6, 2, v25
    v_xor_b32 v7, v7, v24
    v_mul_u32_u24 v6, 3072, v6
    v_lshl_add_u32 v6, v7, 4, v6
    s_sub_u32 s38, s37, 1024
    v_add_u32 v9, s38, v6
    v_add_u32 v5, 128, v0
    v_mul_u32_u24 v6, 171, v5
    v_lshrrev_b32 v6, 12, v6
    v_mul_u32_u24 v7, 24, v6
    v_sub_u32 v7, v5, v7
    v_lshrrev_b32 v25, 1, v6
    v_and_b32 v25, 4, v25
    v_and_or_b32 v24, v6, 2, v25
    v_xor_b32 v7, v7, v24
    v_mul_u32_u24 v6, 3072, v6
    v_lshl_add_u32 v6, v7, 4, v6
    s_sub_u32 s38, s37, 2048
    v_add_u32 v10, s38, v6
    v_add_u32 v5, 192, v0
    v_mul_u32_u24 v6, 171, v5
    v_lshrrev_b32 v6, 12, v6
    v_mul_u32_u24 v7, 24, v6
    v_sub_u32 v7, v5, v7
    v_lshrrev_b32 v25, 1, v6
    v_and_b32 v25, 4, v25
    v_and_or_b32 v24, v6, 2, v25
    v_xor_b32 v7, v7, v24
    v_mul_u32_u24 v6, 3072, v6
    v_lshl_add_u32 v6, v7, 4, v6
    s_sub_u32 s38, s37, 3072
    v_add_u32 v11, s38, v6
    v_add_u32 v5, 256, v0
    v_mul_u32_u24 v6, 171, v5
    v_lshrrev_b32 v6, 12, v6
    v_mul_u32_u24 v7, 24, v6
    v_sub_u32 v7, v5, v7
    v_lshrrev_b32 v25, 1, v6
    v_and_b32 v25, 4, v25
    v_and_or_b32 v24, v6, 2, v25
    v_xor_b32 v7, v7, v24
    v_mul_u32_u24 v6, 3072, v6
    v_lshl_add_u32 v6, v7, 4, v6
    s_sub_u32 s38, s37, 0
    v_add_u32 v12, s38, v6
    v_add_u32 v5, 320, v0
    v_mul_u32_u24 v6, 171, v5
    v_lshrrev_b32 v6, 12, v6
    v_mul_u32_u24 v7, 24, v6
    v_sub_u32 v7, v5, v7
    v_lshrrev_b32 v25, 1, v6
    v_and_b32 v25, 4, v25
    v_and_or_b32 v24, v6, 2, v25
    v_xor_b32 v7, v7, v24
    v_mul_u32_u24 v6, 3072, v6
    v_lshl_add_u32 v6, v7, 4, v6
    s_sub_u32 s38, s37, 1024
    v_add_u32 v13, s38, v6
    s_waitcnt lgkmcnt(0)
    s_mov_b32 s20, s4
    s_mov_b32 s21, s5
    s_mov_b32 s22, 2621440
    s_mov_b32 s23, 0x00020000
    s_mov_b32 s24, s12
    s_mov_b32 s25, s13
    s_mov_b32 s26, 1966080
    s_mov_b32 s27, 0x00020000
    s_mov_b32 s40, 0
    s_mov_b32 s41, 0
    s_mov_b32 s42, 0
    s_mul_i32 s43, s3, 5120
    s_mul_i32 s44, s3, 6144
    s_add_u32 s44, s44, 20480
    s_setprio 3
    s_add_u32 m0, s42, s44
    s_nop 0
    buffer_load_dwordx4 v8, s[24:27], s41 offen offset:0 lds
    buffer_load_dwordx4 v9, s[24:27], s41 offen offset:1024 lds
    buffer_load_dwordx4 v10, s[24:27], s41 offen offset:2048 lds
    buffer_load_dwordx4 v11, s[24:27], s41 offen offset:3072 lds
    s_add_u32 m0, m0, 4096
    s_nop 0
    buffer_load_dwordx4 v12, s[24:27], s41 offen offset:0 lds
    buffer_load_dwordx4 v13, s[24:27], s41 offen offset:1024 lds
    s_add_u32 m0, s42, s43
    s_add_u32 s41, s41, 196608
    buffer_load_dwordx4 v16, s[20:23], s40 offen offset:0 lds
    buffer_load_dwordx4 v17, s[20:23], s40 offen offset:1024 lds
    buffer_load_dwordx4 v18, s[20:23], s40 offen offset:2048 lds
    buffer_load_dwordx4 v19, s[20:23], s40 offen offset:3072 lds
    s_add_u32 m0, m0, 4096
    s_nop 0
    buffer_load_dwordx4 v20, s[20:23], s40 offen offset:0 lds
    s_add_u32 s40, s40, 128
    s_add_u32 s42, s42, 45056
    s_cmp_eq_u32 s42, 135168
    s_cselect_b32 s42, 0, s42
    s_add_u32 m0, s42, s44
    s_nop 0
    buffer_load_dwordx4 v8, s[24:27], s41 offen offset:0 lds
    buffer_load_dwordx4 v9, s[24:27], s41 offen offset:1024 lds
    buffer_load_dwordx4 v10, s[24:27], s41 offen offset:2048 lds
    buffer_load_dwordx4 v11, s[24:27], s41 offen offset:3072 lds
    s_add_u32 m0, m0, 4096
    s_nop 0
    buffer_load_dwordx4 v12, s[24:27], s41 offen offset:0 lds
    v_mov_b32 v56, 0
    v_mov_b32 v57, 0
    v_mov_b32 v58, 0
    v_mov_b32 v59, 0
    v_mov_b32 v60, 0
    v_mov_b32 v61, 0
    v_mov_b32 v62, 0
    v_mov_b32 v63, 0
    v_mov_b32 v64, 0
    v_mov_b32 v65, 0
    v_mov_b32 v66, 0
    v_mov_b32 v67, 0
    v_mov_b32 v68, 0
    v_mov_b32 v69, 0
    v_mov_b32 v70, 0
    v_mov_b32 v71, 0
    v_mov_b32 v72, 0
    v_mov_b32 v73, 0
    v_mov_b32 v74, 0
    v_mov_b32 v75, 0
    v_mov_b32 v76, 0
    v_mov_b32 v77, 0
    v_mov_b32 v78, 0
    v_mov_b32 v79, 0
    v_mov_b32 v80, 0x3f803f80
    v_mov_b32 v81, 0x3f803f80
    v_mov_b32 v82, 0x3f803f80
    v_mov_b32 v83, 0x3f803f80
    v_and_b32 v3, 15, v0
    v_lshrrev_b32 v4, 4, v0
    v_and_b32 v5, 7, v3
    v_xor_b32 v5, v5, v4
    v_lshlrev_b32 v6, 7, v3
    v_lshl_add_u32 v6, v5, 4, v6
    s_mul_i32 s47, s3, 5
    s_add_u32 s47, s47, 1
    s_lshr_b32 s47, s47, 1
    s_min_u32 s47, s47, 7
    s_lshl_b32 s36, s47, 11
    v_add_u32 v1, s36, v6
    v_xor_b32 v2, 64, v1
    s_mov_b32 s45, 0
    s_waitcnt vmcnt(5)
    s_barrier
    buffer_load_dwordx4 v13, s[24:27], s41 offen offset:1024 lds
    s_add_u32 m0, s42, s43
    s_add_u32 s41, s41, 196608
    buffer_load_dwordx4 v16, s[20:23], s40 offen offset:0 lds
    buffer_load_dwordx4 v17, s[20:23], s40 offen offset:1024 lds
    buffer_load_dwordx4 v18, s[20:23], s40 offen offset:2048 lds
    buffer_load_dwordx4 v19, s[20:23], s40 offen offset:3072 lds
    s_add_u32 m0, m0, 4096
    s_nop 0
    buffer_load_dwordx4 v20, s[20:23], s40 offen offset:0 lds
    s_add_u32 s40, s40, 128
    s_add_u32 s42, s42, 45056
    s_cmp_eq_u32 s42, 135168
    s_cselect_b32 s42, 0, s42
    v_add_u32 v3, s45, v1
    v_add_u32 v4, s45, v2
    ds_read_b128 v[32:35], v3 offset:0
    ds_read_b128 v[36:39], v3 offset:2048
    ds_read_b128 v[40:43], v3 offset:4096
    ds_read_b128 v[44:47], v4 offset:0
    ds_read_b128 v[48:51], v4 offset:2048
    ds_read_b128 v[52:55], v4 offset:4096
    s_add_u32 s45, s45, 45056
    s_cmp_eq_u32 s45, 135168
    s_cselect_b32 s45, 0, s45
    s_add_u32 m0, s42, s44
    s_nop 0
    buffer_load_dwordx4 v8, s[24:27], s41 offen offset:0 lds
    s_waitcnt lgkmcnt(5)
    buffer_load_dwordx4 v9, s[24:27], s41 offen offset:1024 lds
    v_mfma_f32_16x16x32_bf16 v[56:59], v[32:35], v[32:35], v[56:59]
    v_mfma_f32_16x16x32_bf16 v[68:71], v[80:83], v[32:35], v[68:71]
    buffer_load_dwordx4 v10, s[24:27], s41 offen offset:2048 lds
    s_waitcnt lgkmcnt(4)
    v_mfma_f32_16x16x32_bf16 v[60:63], v[36:39], v[36:39], v[60:63]
    buffer_load_dwordx4 v11, s[24:27], s41 offen offset:3072 lds
    v_mfma_f32_16x16x32_bf16 v[72:75], v[80:83], v[36:39], v[72:75]
    s_waitcnt lgkmcnt(3)
    s_add_u32 m0, m0, 4096
    s_nop 0
    buffer_load_dwordx4 v12, s[24:27], s41 offen offset:0 lds
    v_mfma_f32_16x16x32_bf16 v[64:67], v[40:43], v[40:43], v[64:67]
    v_mfma_f32_16x16x32_bf16 v[76:79], v[80:83], v[40:43], v[76:79]
    buffer_load_dwordx4 v13, s[24:27], s41 offen offset:1024 lds
    s_waitcnt lgkmcnt(2)
    s_add_u32 m0, s42, s43
    s_add_u32 s41, s41, 196608
    buffer_load_dwordx4 v16, s[20:23], s40 offen offset:0 lds
    v_mfma_f32_16x16x32_bf16 v[56:59], v[44:47], v[44:47], v[56:59]
    v_mfma_f32_16x16x32_bf16 v[68:71], v[80:83], v[44:47], v[68:71]
    buffer_load_dwordx4 v17, s[20:23], s40 offen offset:1024 lds
    s_waitcnt lgkmcnt(1)
    v_mfma_f32_16x16x32_bf16 v[60:63], v[48:51], v[48:51], v[60:63]
    buffer_load_dwordx4 v18, s[20:23], s40 offen offset:2048 lds
    v_mfma_f32_16x16x32_bf16 v[72:75], v[80:83], v[48:51], v[72:75]
    s_waitcnt lgkmcnt(0)
    buffer_load_dwordx4 v19, s[20:23], s40 offen offset:3072 lds
    v_mfma_f32_16x16x32_bf16 v[64:67], v[52:55], v[52:55], v[64:67]
    v_mfma_f32_16x16x32_bf16 v[76:79], v[80:83], v[52:55], v[76:79]
    s_add_u32 m0, m0, 4096
    s_nop 0
    buffer_load_dwordx4 v20, s[20:23], s40 offen offset:0 lds
    s_add_u32 s40, s40, 128
    s_add_u32 s42, s42, 45056
    s_cmp_eq_u32 s42, 135168
    s_cselect_b32 s42, 0, s42
    v_lshrrev_b32 v6, 3, v0
    v_mul_u32_u24 v6, 1280, v6
    v_and_b32 v7, 7, v0
    v_lshl_add_u32 v6, v7, 4, v6
    v_add_u32 v88, 0, v6
    v_add_u32 v89, 9216, v6
    v_add_u32 v90, 18432, v6
    v_add_u32 v91, 27648, v6
    s_lshl_b32 s48, s3, 12
    s_add_u32 s48, s48, 135168
    v_lshrrev_b32 v3, 4, v0
    v_lshrrev_b32 v4, 2, v0
    v_and_b32 v4, 3, v4
    v_and_b32 v5, 3, v0
    v_lshl_add_u32 v6, v3, 3, v4
    v_lshlrev_b32 v6, 7, v6
    v_lshl_add_u32 v6, v5, 3, v6
    v_add_u32 v92, s48, v6
    v_lshl_add_u32 v7, v3, 2, v4
    v_lshlrev_b32 v7, 7, v7
    v_lshl_add_u32 v7, v5, 3, v7
    v_add_u32 v93, s48, v7
    v_lshlrev_b32 v94, 4, v0
    s_mov_b32 s46, 7
fz_f_lloop:
    s_waitcnt vmcnt(11)
    s_barrier
    v_add_u32 v3, s45, v1
    v_add_u32 v4, s45, v2
    ds_read_b128 v[32:35], v3 offset:0
    ds_read_b128 v[36:39], v3 offset:2048
    ds_read_b128 v[40:43], v3 offset:4096
    ds_read_b128 v[44:47], v4 offset:0
    ds_read_b128 v[48:51], v4 offset:2048
    ds_read_b128 v[52:55], v4 offset:4096
    s_add_u32 s45, s45, 45056
    s_cmp_eq_u32 s45, 135168
    s_cselect_b32 s45, 0, s45
    s_add_u32 m0, s42, s44
    s_nop 0
    buffer_load_dwordx4 v8, s[24:27], s41 offen offset:0 lds
    s_waitcnt lgkmcnt(5)
    buffer_load_dwordx4 v9, s[24:27], s41 offen offset:1024 lds
    v_mfma_f32_16x16x32_bf16 v[56:59], v[32:35], v[32:35], v[56:59]
    v_mfma_f32_16x16x32_bf16 v[68:71], v[80:83], v[32:35], v[68:71]
    buffer_load_dwordx4 v10, s[24:27], s41 offen offset:2048 lds
    s_waitcnt lgkmcnt(4)
    v_mfma_f32_16x16x32_bf16 v[60:63], v[36:39], v[36:39], v[60:63]
    buffer_load_dwordx4 v11, s[24:27], s41 offen offset:3072 lds
    v_mfma_f32_16x16x32_bf16 v[72:75], v[80:83], v[36:39], v[72:75]
    s_waitcnt lgkmcnt(3)
    s_add_u32 m0, m0, 4096
    s_nop 0
    buffer_load_dwordx4 v12, s[24:27], s41 offen offset:0 lds
    v_mfma_f32_16x16x32_bf16 v[64:67], v[40:43], v[40:43], v[64:67]
    v_mfma_f32_16x16x32_bf16 v[76:79], v[80:83], v[40:43], v[76:79]
    buffer_load_dwordx4 v13, s[24:27], s41 offen offset:1024 lds
    s_waitcnt lgkmcnt(2)
    s_add_u32 m0, s42, s43
    s_add_u32 s41, s41, 196608
    buffer_load_dwordx4 v16, s[20:23], s40 offen offset:0 lds
    v_mfma_f32_16x16x32_bf16 v[56:59], v[44:47], v[44:47], v[56:59]
    v_mfma_f32_16x16x32_bf16 v[68:71], v[80:83], v[44:47], v[68:71]
    buffer_load_dwordx4 v17, s[20:23], s40 offen offset:1024 lds
    s_waitcnt lgkmcnt(1)
    v_mfma_f32_16x16x32_bf16 v[60:63], v[48:51], v[48:51], v[60:63]
    buffer_load_dwordx4 v18, s[20:23], s40 offen offset:2048 lds
    v_mfma_f32_16x16x32_bf16 v[72:75], v[80:83], v[48:51], v[72:75]
    s_waitcnt lgkmcnt(0)
    buffer_load_dwordx4 v19, s[20:23], s40 offen offset:3072 lds
    v_mfma_f32_16x16x32_bf16 v[64:67], v[52:55], v[52:55], v[64:67]
    v_mfma_f32_16x16x32_bf16 v[76:79], v[80:83], v[52:55], v[76:79]
    s_add_u32 m0, m0, 4096
    s_nop 0
    buffer_load_dwordx4 v20, s[20:23], s40 offen offset:0 lds
    s_add_u32 s40, s40, 128
    s_add_u32 s42, s42, 45056
    s_cmp_eq_u32 s42, 135168
    s_cselect_b32 s42, 0, s42
    s_cmp_eq_u32 s46, 6
    s_cbranch_scc0 fz_side_hook6
    s_sub_u32 s36, s2, 152
    s_lshl_b32 s36, s36, 2
    s_add_u32 s36, s36, s3
    s_mul_hi_u32 s38, s36, 429496730
    s_mul_i32 s39, s38, 10
    s_sub_u32 s39, s36, s39
    s_mov_b32 s70, s38
    s_mov_b32 s71, s39
    s_mov_b32 s72, s36
    s_cmp_lt_u32 s38, 20
    s_cselect_b32 s28, s8, s32
    s_cselect_b32 s29, s9, s33
    s_mov_b32 s30, 1966080
    s_cselect_b32 s30, 819200, s30
    s_mov_b32 s31, 0x00020000
    s_cselect_b32 s49, 0, 20
    s_sub_u32 s49, s38, s49
    s_mul_i32 s49, s49, 40960
    s_lshl_b32 s39, s39, 7
    s_add_u32 s49, s49, s39
    s_cmp_ge_u32 s36, 680
    s_cselect_b32 s49, 0x7ff00000, s49
    s_mov_b32 m0, s48
    s_nop 0
    buffer_load_dwordx4 v88, s[28:31], s49 offen offset:0 lds
    buffer_load_dwordx4 v89, s[28:31], s49 offen offset:1024 lds
    buffer_load_dwordx4 v90, s[28:31], s49 offen offset:2048 lds
    buffer_load_dwordx4 v91, s[28:31], s49 offen offset:3072 lds
fz_side_hook6:
    s_cmp_eq_u32 s46, 4
    s_cbranch_scc0 fz_side_hook4
    s_add_u32 s28, s10, 8912896
    s_addc_u32 s29, s11, 0
    s_mov_b32 s30, 2785280
    s_mov_b32 s31, 0x00020000
    s_cmp_ge_u32 s72, 680
    s_cbranch_scc1 fz_side_skip0
    s_cmp_lt_u32 s70, 20
    s_cbranch_scc1 fz_side_nat0
    ds_read_b64_tr_b16 v[96:97], v93 offset:0
    ds_read_b64_tr_b16 v[98:99], v93 offset:2048
    ds_read_b64_tr_b16 v[100:101], v93 offset:32
    ds_read_b64_tr_b16 v[102:103], v93 offset:2080
    ds_read_b64_tr_b16 v[104:105], v93 offset:64
    ds_read_b64_tr_b16 v[106:107], v93 offset:2112
    ds_read_b64_tr_b16 v[108:109], v93 offset:96
    ds_read_b64_tr_b16 v[110:111], v93 offset:2144
    s_branch fz_side_join0
fz_side_nat0:
    ds_read_b64_tr_b16 v[96:97], v92 offset:0
    ds_read_b64_tr_b16 v[98:99], v92 offset:512
    ds_read_b64_tr_b16 v[100:101], v92 offset:32
    ds_read_b64_tr_b16 v[102:103], v92 offset:544
    ds_read_b64_tr_b16 v[104:105], v92 offset:64
    ds_read_b64_tr_b16 v[106:107], v92 offset:576
    ds_read_b64_tr_b16 v[108:109], v92 offset:96
    ds_read_b64_tr_b16 v[110:111], v92 offset:608
fz_side_join0:
    s_lshl_b32 s36, s71, 2
    s_add_u32 s36, s36, 0
    s_mul_hi_u32 s37, s36, 858993460
    s_mul_i32 s38, s37, 5
    s_sub_u32 s38, s36, s38
    s_mul_i32 s37, s37, 68
    s_add_u32 s37, s37, s70
    s_mul_i32 s37, s37, 5
    s_add_u32 s37, s37, s38
    s_lshl_b32 s37, s37, 10
    s_waitcnt lgkmcnt(6)
    buffer_store_dwordx4 v[96:99], v94, s[28:31], s37 offen sc1
    s_lshl_b32 s36, s71, 2
    s_add_u32 s36, s36, 1
    s_mul_hi_u32 s37, s36, 858993460
    s_mul_i32 s38, s37, 5
    s_sub_u32 s38, s36, s38
    s_mul_i32 s37, s37, 68
    s_add_u32 s37, s37, s70
    s_mul_i32 s37, s37, 5
    s_add_u32 s37, s37, s38
    s_lshl_b32 s37, s37, 10
    s_waitcnt lgkmcnt(4)
    buffer_store_dwordx4 v[100:103], v94, s[28:31], s37 offen sc1
    s_lshl_b32 s36, s71, 2
    s_add_u32 s36, s36, 2
    s_mul_hi_u32 s37, s36, 858993460
    s_mul_i32 s38, s37, 5
    s_sub_u32 s38, s36, s38
    s_mul_i32 s37, s37, 68
    s_add_u32 s37, s37, s70
    s_mul_i32 s37, s37, 5
    s_add_u32 s37, s37, s38
    s_lshl_b32 s37, s37, 10
    s_waitcnt lgkmcnt(2)
    buffer_store_dwordx4 v[104:107], v94, s[28:31], s37 offen sc1
    s_lshl_b32 s36, s71, 2
    s_add_u32 s36, s36, 3
    s_mul_hi_u32 s37, s36, 858993460
    s_mul_i32 s38, s37, 5
    s_sub_u32 s38, s36, s38
    s_mul_i32 s37, s37, 68
    s_add_u32 s37, s37, s70
    s_mul_i32 s37, s37, 5
    s_add_u32 s37, s37, s38
    s_lshl_b32 s37, s37, 10
    s_waitcnt lgkmcnt(0)
    buffer_store_dwordx4 v[108:111], v94, s[28:31], s37 offen sc1
    s_nop 1
fz_side_skip0:
    s_sub_u32 s36, s2, 152
    s_lshl_b32 s36, s36, 2
    s_add_u32 s36, s36, s3
    s_add_u32 s36, s36, 416
    s_mul_hi_u32 s38, s36, 429496730
    s_mul_i32 s39, s38, 10
    s_sub_u32 s39, s36, s39
    s_mov_b32 s70, s38
    s_mov_b32 s71, s39
    s_mov_b32 s72, s36
    s_cmp_lt_u32 s38, 20
    s_cselect_b32 s28, s8, s32
    s_cselect_b32 s29, s9, s33
    s_mov_b32 s30, 1966080
    s_cselect_b32 s30, 819200, s30
    s_mov_b32 s31, 0x00020000
    s_cselect_b32 s49, 0, 20
    s_sub_u32 s49, s38, s49
    s_mul_i32 s49, s49, 40960
    s_lshl_b32 s39, s39, 7
    s_add_u32 s49, s49, s39
    s_cmp_ge_u32 s36, 680
    s_cselect_b32 s49, 0x7ff00000, s49
    s_mov_b32 m0, s48
    s_nop 0
    buffer_load_dwordx4 v88, s[28:31], s49 offen offset:0 lds
    buffer_load_dwordx4 v89, s[28:31], s49 offen offset:1024 lds
    buffer_load_dwordx4 v90, s[28:31], s49 offen offset:2048 lds
    buffer_load_dwordx4 v91, s[28:31], s49 offen offset:3072 lds
fz_side_hook4:
    s_cmp_eq_u32 s46, 2
    s_cbranch_scc0 fz_side_hook2
    s_add_u32 s28, s10, 8912896
    s_addc_u32 s29, s11, 0
    s_mov_b32 s30, 2785280
    s_mov_b32 s31, 0x00020000
    s_cmp_ge_u32 s72, 680
    s_cbranch_scc1 fz_side_skip1
    s_cmp_lt_u32 s70, 20
    s_cbranch_scc1 fz_side_nat1
    ds_read_b64_tr_b16 v[96:97], v93 offset:0
    ds_read_b64_tr_b16 v[98:99], v93 offset:2048
    ds_read_b64_tr_b16 v[100:101], v93 offset:32
    ds_read_b64_tr_b16 v[102:103], v93 offset:2080
    ds_read_b64_tr_b16 v[104:105], v93 offset:64
    ds_read_b64_tr_b16 v[106:107], v93 offset:2112
    ds_read_b64_tr_b16 v[108:109], v93 offset:96
    ds_read_b64_tr_b16 v[110:111], v93 offset:2144
    s_branch fz_side_join1
fz_side_nat1:
    ds_read_b64_tr_b16 v[96:97], v92 offset:0
    ds_read_b64_tr_b16 v[98:99], v92 offset:512
    ds_read_b64_tr_b16 v[100:101], v92 offset:32
    ds_read_b64_tr_b16 v[102:103], v92 offset:544
    ds_read_b64_tr_b16 v[104:105], v92 offset:64
    ds_read_b64_tr_b16 v[106:107], v92 offset:576
    ds_read_b64_tr_b16 v[108:109], v92 offset:96
    ds_read_b64_tr_b16 v[110:111], v92 offset:608
fz_side_join1:
    s_lshl_b32 s36, s71, 2
    s_add_u32 s36, s36, 0
    s_mul_hi_u32 s37, s36, 858993460
    s_mul_i32 s38, s37, 5
    s_sub_u32 s38, s36, s38
    s_mul_i32 s37, s37, 68
    s_add_u32 s37, s37, s70
    s_mul_i32 s37, s37, 5
    s_add_u32 s37, s37, s38
    s_lshl_b32 s37, s37, 10
    s_waitcnt lgkmcnt(6)
    buffer_store_dwordx4 v[96:99], v94, s[28:31], s37 offen sc1
    s_lshl_b32 s36, s71, 2
    s_add_u32 s36, s36, 1
    s_mul_hi_u32 s37, s36, 858993460
    s_mul_i32 s38, s37, 5
    s_sub_u32 s38, s36, s38
    s_mul_i32 s37, s37, 68
    s_add_u32 s37, s37, s70
    s_mul_i32 s37, s37, 5
    s_add_u32 s37, s37, s38
    s_lshl_b32 s37, s37, 10
    s_waitcnt lgkmcnt(4)
    buffer_store_dwordx4 v[100:103], v94, s[28:31], s37 offen sc1
    s_lshl_b32 s36, s71, 2
    s_add_u32 s36, s36, 2
    s_mul_hi_u32 s37, s36, 858993460
    s_mul_i32 s38, s37, 5
    s_sub_u32 s38, s36, s38
    s_mul_i32 s37, s37, 68
    s_add_u32 s37, s37, s70
    s_mul_i32 s37, s37, 5
    s_add_u32 s37, s37, s38
    s_lshl_b32 s37, s37, 10
    s_waitcnt lgkmcnt(2)
    buffer_store_dwordx4 v[104:107], v94, s[28:31], s37 offen sc1
    s_lshl_b32 s36, s71, 2
    s_add_u32 s36, s36, 3
    s_mul_hi_u32 s37, s36, 858993460
    s_mul_i32 s38, s37, 5
    s_sub_u32 s38, s36, s38
    s_mul_i32 s37, s37, 68
    s_add_u32 s37, s37, s70
    s_mul_i32 s37, s37, 5
    s_add_u32 s37, s37, s38
    s_lshl_b32 s37, s37, 10
    s_waitcnt lgkmcnt(0)
    buffer_store_dwordx4 v[108:111], v94, s[28:31], s37 offen sc1
    s_nop 1
fz_side_skip1:
fz_side_hook2:
    s_sub_u32 s46, s46, 1
    s_cmp_lg_u32 s46, 0
    s_cbranch_scc1 fz_f_lloop
    s_waitcnt vmcnt(11)
    s_barrier
    s_cmp_lg_u32 s3, 0
    s_cbranch_scc1 fz_wtc_in
    s_mov_b32 s84, s34
    s_mov_b32 s85, s35
    s_mov_b32 s86, 256
    s_mov_b32 s87, 0x00020000
    v_mov_b32 v3, 0
    v_mov_b32 v4, 1
    s_mov_b64 exec, 1
    buffer_atomic_add v4, v3, s[84:87], 0 offen sc1
    s_mov_b64 exec, -1
    v_add_u32 v3, s45, v1
    v_add_u32 v4, s45, v2
    ds_read_b128 v[32:35], v3 offset:0
    ds_read_b128 v[36:39], v3 offset:2048
    ds_read_b128 v[40:43], v3 offset:4096
    ds_read_b128 v[44:47], v4 offset:0
    ds_read_b128 v[48:51], v4 offset:2048
    ds_read_b128 v[52:55], v4 offset:4096
    s_add_u32 s45, s45, 45056
    s_cmp_eq_u32 s45, 135168
    s_cselect_b32 s45, 0, s45
    s_waitcnt lgkmcnt(5)
    v_mfma_f32_16x16x32_bf16 v[56:59], v[32:35], v[32:35], v[56:59]
    v_mfma_f32_16x16x32_bf16 v[68:71], v[80:83], v[32:35], v[68:71]
    s_waitcnt lgkmcnt(4)
    v_mfma_f32_16x16x32_bf16 v[60:63], v[36:39], v[36:39], v[60:63]
    v_mfma_f32_16x16x32_bf16 v[72:75], v[80:83], v[36:39], v[72:75]
    s_waitcnt lgkmcnt(3)
    v_mfma_f32_16x16x32_bf16 v[64:67], v[40:43], v[40:43], v[64:67]
    v_mfma_f32_16x16x32_bf16 v[76:79], v[80:83], v[40:43], v[76:79]
    s_waitcnt lgkmcnt(2)
    v_mfma_f32_16x16x32_bf16 v[56:59], v[44:47], v[44:47], v[56:59]
    v_mfma_f32_16x16x32_bf16 v[68:71], v[80:83], v[44:47], v[68:71]
    s_waitcnt lgkmcnt(1)
    v_mfma_f32_16x16x32_bf16 v[60:63], v[48:51], v[48:51], v[60:63]
    v_mfma_f32_16x16x32_bf16 v[72:75], v[80:83], v[48:51], v[72:75]
    s_waitcnt lgkmcnt(0)
    v_mfma_f32_16x16x32_bf16 v[64:67], v[52:55], v[52:55], v[64:67]
    v_mfma_f32_16x16x32_bf16 v[76:79], v[80:83], v[52:55], v[76:79]
    s_waitcnt vmcnt(1)
    s_branch fz_wtc_in_j
fz_wtc_in:
    v_add_u32 v3, s45, v1
    v_add_u32 v4, s45, v2
    ds_read_b128 v[32:35], v3 offset:0
    ds_read_b128 v[36:39], v3 offset:2048
    ds_read_b128 v[40:43], v3 offset:4096
    ds_read_b128 v[44:47], v4 offset:0
    ds_read_b128 v[48:51], v4 offset:2048
    ds_read_b128 v[52:55], v4 offset:4096
    s_add_u32 s45, s45, 45056
    s_cmp_eq_u32 s45, 135168
    s_cselect_b32 s45, 0, s45
    s_waitcnt lgkmcnt(5)
    v_mfma_f32_16x16x32_bf16 v[56:59], v[32:35], v[32:35], v[56:59]
    v_mfma_f32_16x16x32_bf16 v[68:71], v[80:83], v[32:35], v[68:71]
    s_waitcnt lgkmcnt(4)
    v_mfma_f32_16x16x32_bf16 v[60:63], v[36:39], v[36:39], v[60:63]
    v_mfma_f32_16x16x32_bf16 v[72:75], v[80:83], v[36:39], v[72:75]
    s_waitcnt lgkmcnt(3)
    v_mfma_f32_16x16x32_bf16 v[64:67], v[40:43], v[40:43], v[64:67]
    v_mfma_f32_16x16x32_bf16 v[76:79], v[80:83], v[40:43], v[76:79]
    s_waitcnt lgkmcnt(2)
    v_mfma_f32_16x16x32_bf16 v[56:59], v[44:47], v[44:47], v[56:59]
    v_mfma_f32_16x16x32_bf16 v[68:71], v[80:83], v[44:47], v[68:71]
    s_waitcnt lgkmcnt(1)
    v_mfma_f32_16x16x32_bf16 v[60:63], v[48:51], v[48:51], v[60:63]
    v_mfma_f32_16x16x32_bf16 v[72:75], v[80:83], v[48:51], v[72:75]
    s_waitcnt lgkmcnt(0)
    v_mfma_f32_16x16x32_bf16 v[64:67], v[52:55], v[52:55], v[64:67]
    v_mfma_f32_16x16x32_bf16 v[76:79], v[80:83], v[52:55], v[76:79]
    s_waitcnt vmcnt(0)
fz_wtc_in_j:
    s_barrier
    v_add_u32 v3, s45, v1
    v_add_u32 v4, s45, v2
    ds_read_b128 v[32:35], v3 offset:0
    ds_read_b128 v[36:39], v3 offset:2048
    ds_read_b128 v[40:43], v3 offset:4096
    ds_read_b128 v[44:47], v4 offset:0
    ds_read_b128 v[48:51], v4 offset:2048
    ds_read_b128 v[52:55], v4 offset:4096
    s_add_u32 s45, s45, 45056
    s_cmp_eq_u32 s45, 135168
    s_cselect_b32 s45, 0, s45
    s_waitcnt lgkmcnt(5)
    v_mfma_f32_16x16x32_bf16 v[56:59], v[32:35], v[32:35], v[56:59]
    v_mfma_f32_16x16x32_bf16 v[68:71], v[80:83], v[32:35], v[68:71]
    s_waitcnt lgkmcnt(4)
    v_mfma_f32_16x16x32_bf16 v[60:63], v[36:39], v[36:39], v[60:63]
    v_mfma_f32_16x16x32_bf16 v[72:75], v[80:83], v[36:39], v[72:75]
    s_waitcnt lgkmcnt(3)
    v_mfma_f32_16x16x32_bf16 v[64:67], v[40:43], v[40:43], v[64:67]
    v_mfma_f32_16x16x32_bf16 v[76:79], v[80:83], v[40:43], v[76:79]
    s_waitcnt lgkmcnt(2)
    v_mfma_f32_16x16x32_bf16 v[56:59], v[44:47], v[44:47], v[56:59]
    v_mfma_f32_16x16x32_bf16 v[68:71], v[80:83], v[44:47], v[68:71]
    s_waitcnt lgkmcnt(1)
    v_mfma_f32_16x16x32_bf16 v[60:63], v[48:51], v[48:51], v[60:63]
    v_mfma_f32_16x16x32_bf16 v[72:75], v[80:83], v[48:51], v[72:75]
    s_waitcnt lgkmcnt(0)
    v_mfma_f32_16x16x32_bf16 v[64:67], v[52:55], v[52:55], v[64:67]
    v_mfma_f32_16x16x32_bf16 v[76:79], v[80:83], v[52:55], v[76:79]
    s_mov_b32 s52, 0x22222222
    s_mov_b32 s53, 0x22222222
    s_mov_b32 s54, 0x44444444
    s_mov_b32 s55, 0x44444444
    s_mov_b32 s56, 0x88888888
    s_mov_b32 s57, 0x88888888
    s_nop 7
    v_cndmask_b32 v56, v56, v57, s[52:53]
    v_cndmask_b32 v56, v56, v58, s[54:55]
    v_cndmask_b32 v56, v56, v59, s[56:57]
    v_cndmask_b32 v60, v60, v61, s[52:53]
    v_cndmask_b32 v60, v60, v62, s[54:55]
    v_cndmask_b32 v60, v60, v63, s[56:57]
    v_cndmask_b32 v64, v64, v65, s[52:53]
    v_cndmask_b32 v64, v64, v66, s[54:55]
    v_cndmask_b32 v64, v64, v67, s[56:57]
    v_mul_f32 v68, 0x3acccccd, v68
    v_mul_f32 v72, 0x3acccccd, v72
    v_mul_f32 v76, 0x3acccccd, v76
    v_mul_f32 v56, 0x3acccccd, v56
    v_mul_f32 v60, 0x3acccccd, v60
    v_mul_f32 v64, 0x3acccccd, v64
    v_fma_f32 v56, -v68, v68, v56
    v_fma_f32 v60, -v72, v72, v60
    v_fma_f32 v64, -v76, v76, v64
    v_max_f32 v56, 0, v56
    v_max_f32 v60, 0, v60
    v_max_f32 v64, 0, v64
    v_cvt_pk_bf16_f32 v68, v68, v68
    v_lshlrev_b32 v68, 16, v68
    v_cvt_pk_bf16_f32 v56, v56, v56
    v_lshlrev_b32 v56, 16, v56
    v_cvt_pk_bf16_f32 v72, v72, v72
    v_lshlrev_b32 v72, 16, v72
    v_cvt_pk_bf16_f32 v60, v60, v60
    v_lshlrev_b32 v60, 16, v60
    v_cvt_pk_bf16_f32 v76, v76, v76
    v_lshlrev_b32 v76, 16, v76
    v_cvt_pk_bf16_f32 v64, v64, v64
    v_lshlrev_b32 v64, 16, v64
    v_add_f32 v56, 0x3727c5ac, v56
    v_add_f32 v60, 0x3727c5ac, v60
    v_add_f32 v64, 0x3727c5ac, v64
    v_cvt_pk_bf16_f32 v56, v56, v56
    v_lshlrev_b32 v56, 16, v56
    v_cvt_pk_bf16_f32 v60, v60, v60
    v_lshlrev_b32 v60, 16, v60
    v_cvt_pk_bf16_f32 v64, v64, v64
    v_lshlrev_b32 v64, 16, v64
    v_sqrt_f32 v56, v56
    v_sqrt_f32 v60, v60
    v_sqrt_f32 v64, v64
    s_nop 0
    v_cvt_pk_bf16_f32 v56, v56, v56
    v_lshlrev_b32 v56, 16, v56
    v_cvt_pk_bf16_f32 v60, v60, v60
    v_lshlrev_b32 v60, 16, v60
    v_cvt_pk_bf16_f32 v64, v64, v64
    v_lshlrev_b32 v64, 16, v64
    v_rcp_f32 v69, v56
    v_rcp_f32 v73, v60
    v_rcp_f32 v77, v64
    v_and_b32 v3, 15, v0
    v_lshlrev_b32 v3, 3, v3
    v_mul_f32 v68, v68, v69
    v_mul_f32 v72, v72, v73
    v_mul_f32 v76, v76, v77
    v_sub_f32 v68, 0, v68
    v_sub_f32 v72, 0, v72
    v_sub_f32 v76, 0, v76
    s_lshl_b32 s36, s47, 7
    s_add_u32 s36, s36, 151552
    v_add_u32 v3, s36, v3
    s_mov_b32 s52, 0x00f0000f
    s_mov_b32 s53, 0xf0000f00
    s_mov_b64 exec, s[52:53]
    ds_write_b64 v3, v[68:69] offset:0
    ds_write_b64 v3, v[72:73] offset:128
    ds_write_b64 v3, v[76:77] offset:256
    s_mov_b64 exec, -1
    s_waitcnt lgkmcnt(0)
    s_barrier
    s_barrier
    s_mov_b32 s84, s34
    s_mov_b32 s85, s35
    s_mov_b32 s86, 256
    s_mov_b32 s87, 0x00020000
    v_mov_b32 v3, 128
    s_mov_b32 s83, 20000
fz_nonce_f:
    buffer_load_dword v4, v3, s[84:87], 0 offen sc1
    s_waitcnt vmcnt(0)
    v_readfirstlane_b32 s82, v4
    s_nop 3
    s_cmp_lg_u32 s82, 0
    s_cbranch_scc1 fz_nonce_ok_f
    s_sleep 2
    s_sub_u32 s83, s83, 1
    s_cmp_lg_u32 s83, 0
    s_cbranch_scc1 fz_nonce_f
fz_nonce_ok_f:
    s_and_b32 s12, s2, 7
    s_lshr_b32 s13, s2, 3
    s_and_b32 s14, s12, 1
    s_lshl_b32 s14, s14, 2
    s_and_b32 s16, s13, 3
    s_add_u32 s14, s14, s16
    s_lshr_b32 s15, s12, 1
    s_lshl_b32 s15, s15, 3
    s_lshr_b32 s16, s13, 2
    s_add_u32 s15, s15, s16
    v_lshlrev_b32 v2, 4, v0
    s_mov_b32 s20, s10
    s_mov_b32 s21, s11
    s_mov_b32 s22, 8912896
    s_mov_b32 s23, 0x00020000
    s_add_u32 s24, s10, 8912896
    s_addc_u32 s25, s11, 0
    s_mov_b32 s26, 2785280
    s_mov_b32 s27, 0x00020000
    s_lshl_b32 s40, s15, 2
    s_add_u32 s40, s40, s3
    s_mul_i32 s40, s40, 69632
    s_mul_i32 s41, s14, 348160
    s_mul_i32 s43, s3, 5120
    s_add_u32 s41, s41, s43
    s_lshl_b32 s44, s3, 12
    s_add_u32 s44, s44, 20480
    s_mov_b32 s42, 0
    s_mov_b32 s45, 0
    s_lshl_b32 s36, s15, 6
    s_add_u32 s37, s36, 63
    s_mul_hi_u32 s46, s36, 38347923
    s_mul_hi_u32 s47, s37, 38347923
    v_and_b32 v5, 7, v0
    v_mov_b32 v7, s46
    v_mov_b32 v8, s47
    v_cmp_le_u32 vcc, 8, v0
    s_nop 1
    v_cndmask_b32 v7, v7, v8, vcc
    v_and_b32 v8, 1, v5
    v_lshl_add_u32 v7, v7, 1, v8
    v_cmp_le_u32 vcc, 19, v7
    v_subrev_u32 v10, 19, v7
    v_mov_b32 v9, 0
    v_mov_b32 v11, 4
    v_cndmask_b32 v7, v7, v10, vcc
    v_cndmask_b32 v9, v9, v11, vcc
    v_add_u32 v7, 0, v7
    v_lshrrev_b32 v5, 1, v5
    v_add_u32 v5, v5, v9
    v_lshl_add_u32 v7, v7, 3, v5
    v_lshlrev_b32 v240, 7, v7
    v_mov_b32 v241, v2
    s_cmp_lg_u32 s2, 255
    s_cbranch_scc1 fz_wtc_skip
    s_cmp_lg_u32 s3, 3
    s_cbranch_scc1 fz_wtc_skip
    s_mov_b32 s84, s34
    s_mov_b32 s85, s35
    s_mov_b32 s86, 256
    s_mov_b32 s87, 0x00020000
    v_mov_b32 v3, 0
    s_mov_b32 s83, 20000
fz_wtc_poll:
    buffer_load_dword v4, v3, s[84:87], 0 offen sc1
    s_waitcnt vmcnt(0)
    v_readfirstlane_b32 s36, v4
    s_nop 3
    s_cmp_ge_u32 s36, 104
    s_cbranch_scc1 fz_wtc_ok
    s_sleep 2
    s_sub_u32 s83, s83, 1
    s_cmp_lg_u32 s83, 0
    s_cbranch_scc1 fz_wtc_poll
fz_wtc_ok:
    s_add_u32 s84, s10, 11698176
    s_addc_u32 s85, s11, 0
    s_mov_b32 s86, 36864
    s_mov_b32 s87, 0x00020000
    v_lshlrev_b32 v3, 7, v0
    v_add_u32 v3, 32768, v3
    v_mov_b32 v4, s82
    buffer_store_dword v4, v3, s[84:87], 0 offen sc1
fz_wtc_skip:
    s_add_u32 s84, s10, 11698176
    s_addc_u32 s85, s11, 0
    s_mov_b32 s86, 36864
    s_mov_b32 s87, 0x00020000
    s_and_b32 s36, s2, 31
    s_lshl_b32 s36, s36, 7
    s_add_u32 s36, s36, 32768
    v_mov_b32 v3, s36
    s_mov_b32 s83, 20000
fz_p2_wt_pollf:
    buffer_load_dword v4, v3, s[84:87], 0 offen sc1
    s_waitcnt vmcnt(0)
    v_readfirstlane_b32 s36, v4
    s_nop 3
    s_cmp_eq_u32 s36, s82
    s_cbranch_scc1 fz_p2_wt_okf
    s_sleep 8
    s_sub_u32 s83, s83, 1
    s_cmp_lg_u32 s83, 0
    s_cbranch_scc1 fz_p2_wt_pollf
fz_p2_wt_okf:
    s_add_u32 m0, s42, s43
    s_add_u32 s39, s41, 4096
    buffer_load_dwordx4 v2, s[24:27], s41 offen offset:0 lds
    buffer_load_dwordx4 v2, s[24:27], s41 offen offset:1024 lds
    buffer_load_dwordx4 v2, s[24:27], s41 offen offset:2048 lds
    buffer_load_dwordx4 v2, s[24:27], s41 offen offset:3072 lds
    s_add_u32 m0, m0, 4096
    s_add_u32 s41, s41, 20480
    buffer_load_dwordx4 v2, s[24:27], s39 offen lds
    s_add_u32 s42, s42, 36864
    s_cmp_eq_u32 s42, 147456
    s_cselect_b32 s42, 0, s42
    s_add_u32 m0, s42, s43
    s_add_u32 s39, s41, 4096
    buffer_load_dwordx4 v2, s[24:27], s41 offen offset:0 lds
    buffer_load_dwordx4 v2, s[24:27], s41 offen offset:1024 lds
    buffer_load_dwordx4 v2, s[24:27], s41 offen offset:2048 lds
    buffer_load_dwordx4 v2, s[24:27], s41 offen offset:3072 lds
    s_add_u32 m0, m0, 4096
    s_add_u32 s41, s41, 20480
    buffer_load_dwordx4 v2, s[24:27], s39 offen lds
    s_add_u32 s42, s42, 36864
    s_cmp_eq_u32 s42, 147456
    s_cselect_b32 s42, 0, s42
    s_add_u32 m0, s42, s43
    s_add_u32 s39, s41, 4096
    buffer_load_dwordx4 v2, s[24:27], s41 offen offset:0 lds
    buffer_load_dwordx4 v2, s[24:27], s41 offen offset:1024 lds
    buffer_load_dwordx4 v2, s[24:27], s41 offen offset:2048 lds
    buffer_load_dwordx4 v2, s[24:27], s41 offen offset:3072 lds
    s_add_u32 m0, m0, 4096
    s_add_u32 s41, s41, 20480
    buffer_load_dwordx4 v2, s[24:27], s39 offen lds
    s_add_u32 s42, s42, 36864
    s_cmp_eq_u32 s42, 147456
    s_cselect_b32 s42, 0, s42
    s_barrier
    s_mov_b32 s83, 20000
fz_pf_qf:
    buffer_load_dword v4, v240, s[84:87], 0 offen sc1
    s_waitcnt vmcnt(0)
    v_cmp_ne_u32 vcc, s82, v4
    s_nop 4
    s_and_b32 s36, vcc_lo, 0xffff
    s_cmp_eq_u32 s36, 0
    s_cbranch_scc1 fz_pf_ok_qf
    s_sleep 16
    s_sub_u32 s83, s83, 1
    s_cmp_lg_u32 s83, 0
    s_cbranch_scc1 fz_pf_qf
fz_pf_ok_qf:
    s_add_u32 m0, s45, s44
    s_add_u32 s45, s45, 36864
    buffer_load_dwordx4 v2, s[20:23], s40 offen offset:0 lds
    buffer_load_dwordx4 v2, s[20:23], s40 offen offset:1024 lds
    buffer_load_dwordx4 v2, s[20:23], s40 offen offset:2048 lds
    buffer_load_dwordx4 v2, s[20:23], s40 offen offset:3072 lds
    s_add_u32 s40, s40, 4096
    s_cmp_eq_u32 s45, 147456
    s_cselect_b32 s45, 0, s45
    s_add_u32 m0, s45, s44
    s_add_u32 s45, s45, 36864
    buffer_load_dwordx4 v2, s[20:23], s40 offen offset:0 lds
    buffer_load_dwordx4 v2, s[20:23], s40 offen offset:1024 lds
    buffer_load_dwordx4 v2, s[20:23], s40 offen offset:2048 lds
    buffer_load_dwordx4 v2, s[20:23], s40 offen offset:3072 lds
    s_add_u32 s40, s40, 4096
    s_cmp_eq_u32 s45, 147456
    s_cselect_b32 s45, 0, s45
    s_add_u32 m0, s45, s44
    s_add_u32 s45, s45, 36864
    buffer_load_dwordx4 v2, s[20:23], s40 offen offset:0 lds
    buffer_load_dwordx4 v2, s[20:23], s40 offen offset:1024 lds
    buffer_load_dwordx4 v2, s[20:23], s40 offen offset:2048 lds
    buffer_load_dwordx4 v2, s[20:23], s40 offen offset:3072 lds
    s_add_u32 s40, s40, 4096
    s_cmp_eq_u32 s45, 147456
    s_cselect_b32 s45, 0, s45
    s_branch fz_p2_lcommon
fz_phase2:
    s_and_b32 s12, s2, 7
    s_lshr_b32 s13, s2, 3
    s_and_b32 s14, s12, 1
    s_lshl_b32 s14, s14, 2
    s_and_b32 s16, s13, 3
    s_add_u32 s14, s14, s16
    s_lshr_b32 s15, s12, 1
    s_lshl_b32 s15, s15, 3
    s_lshr_b32 s16, s13, 2
    s_add_u32 s15, s15, s16
    v_lshlrev_b32 v2, 4, v0
    s_mov_b32 s3, s19
    s_cmp_lg_u32 s3, 0
    s_cbranch_scc1 fz_p2_nonce_skip
    s_mov_b32 s84, s34
    s_mov_b32 s85, s35
    s_mov_b32 s86, 256
    s_mov_b32 s87, 0x00020000
    v_mov_b32 v3, 128
    s_mov_b32 s83, 20000
fz_nonce_c:
    buffer_load_dword v4, v3, s[84:87], 0 offen sc1
    s_waitcnt vmcnt(0)
    v_readfirstlane_b32 s82, v4
    s_nop 3
    s_cmp_lg_u32 s82, 0
    s_cbranch_scc1 fz_nonce_ok_c
    s_sleep 2
    s_sub_u32 s83, s83, 1
    s_cmp_lg_u32 s83, 0
    s_cbranch_scc1 fz_nonce_c
fz_nonce_ok_c:
fz_p2_nonce_skip:
    s_waitcnt vmcnt(0) lgkmcnt(0)
    s_barrier
    s_cmp_lg_u32 s3, 0
    s_cbranch_scc1 fz_p2_flag_skip
    s_add_u32 s84, s10, 11698176
    s_addc_u32 s85, s11, 0
    s_mov_b32 s86, 36864
    s_mov_b32 s87, 0x00020000
    s_lshl_b32 s83, s2, 7
    v_mov_b32 v3, s83
    v_mov_b32 v4, s82
    s_mov_b64 exec, 1
    buffer_store_dword v4, v3, s[84:87], 0 offen sc1
    s_mov_b64 exec, -1
    s_lshl_b32 s36, s15, 6
    s_add_u32 s37, s36, 63
    s_mul_hi_u32 s46, s36, 26843546
    s_mul_hi_u32 s47, s37, 26843546
    v_and_b32 v5, 7, v0
    v_mov_b32 v7, s46
    v_mov_b32 v8, s47
    v_cmp_le_u32 vcc, 8, v0
    s_nop 1
    v_cndmask_b32 v7, v7, v8, vcc
    v_and_b32 v8, 1, v5
    v_lshl_add_u32 v7, v7, 1, v8
    v_cmp_le_u32 vcc, 13, v7
    v_subrev_u32 v10, 13, v7
    v_mov_b32 v9, 0
    v_mov_b32 v11, 4
    v_cndmask_b32 v7, v7, v10, vcc
    v_cndmask_b32 v9, v9, v11, vcc
    v_add_u32 v7, 19, v7
    v_lshrrev_b32 v5, 1, v5
    v_add_u32 v5, v5, v9
    v_lshl_add_u32 v7, v7, 3, v5
    v_lshlrev_b32 v150, 7, v7
fz_p2_flag_skip:
    s_mov_b32 s32, s80
    s_mov_b32 s33, s81
    s_mov_b32 s34, 2621440
    s_mov_b32 s35, 0x00020000
    v_mov_b32 v104, 0
    v_mov_b32 v105, 0
    v_mov_b32 v106, 0
    v_mov_b32 v107, 0
    v_mov_b32 v108, 0
    v_mov_b32 v109, 0
    v_mov_b32 v110, 0
    v_mov_b32 v111, 0
    v_mov_b32 v112, 0
    v_mov_b32 v113, 0
    v_mov_b32 v114, 0
    v_mov_b32 v115, 0
    v_mov_b32 v116, 0
    v_mov_b32 v117, 0
    v_mov_b32 v118, 0
    v_mov_b32 v119, 0
    v_mov_b32 v120, 0
    v_mov_b32 v121, 0
    v_mov_b32 v122, 0
    v_mov_b32 v123, 0
    v_mov_b32 v124, 0
    v_mov_b32 v125, 0
    v_mov_b32 v126, 0
    v_mov_b32 v127, 0
    v_mov_b32 v128, 0
    v_mov_b32 v129, 0
    v_mov_b32 v130, 0
    v_mov_b32 v131, 0
    v_mov_b32 v132, 0
    v_mov_b32 v133, 0
    v_mov_b32 v134, 0
    v_mov_b32 v135, 0
    v_mov_b32 v136, 0
    v_mov_b32 v137, 0
    v_mov_b32 v138, 0
    v_mov_b32 v139, 0
    v_mov_b32 v140, 0
    v_mov_b32 v141, 0
    v_mov_b32 v142, 0
    v_mov_b32 v143, 0
    s_lshl_b32 s16, s3, 12
    s_add_u32 s16, s16, 20480
    s_mov_b32 s17, 0
    v_add_u32 v5, s16, v2
    v_mov_b32 v1, v2
    v_mov_b32 v3, v1
    v_mov_b32 v4, v5
    v_and_b32 v6, 15, v0
    v_lshrrev_b32 v7, 4, v0
    v_mul_u32_u24 v6, 160, v6
    v_lshl_add_u32 v6, v7, 3, v6
    s_mul_i32 s36, s3, 2560
    s_add_u32 s36, s36, 147456
    v_add_u32 v6, s36, v6
    v_add_u32 v7, s36, v2
    s_lshl_b32 s36, s15, 6
    s_lshl_b32 s37, s3, 4
    s_add_u32 s36, s36, s37
    s_mul_i32 s36, s36, 1280
    s_mul_i32 s37, s14, 160
    s_add_u32 s36, s36, s37
    v_add_u32 v8, 0, v0
    v_mul_u32_u24 v9, 205, v8
    v_lshrrev_b32 v9, 11, v9
    v_mul_u32_u24 v10, 10, v9
    v_sub_u32 v10, v8, v10
    v_mul_u32_u24 v9, 1280, v9
    v_lshl_add_u32 v9, v10, 4, v9
    v_add_u32 v144, s36, v9
    v_add_u32 v8, 64, v0
    v_mul_u32_u24 v9, 205, v8
    v_lshrrev_b32 v9, 11, v9
    v_mul_u32_u24 v10, 10, v9
    v_sub_u32 v10, v8, v10
    v_mul_u32_u24 v9, 1280, v9
    v_lshl_add_u32 v9, v10, 4, v9
    v_add_u32 v145, s36, v9
    v_add_u32 v8, 128, v0
    v_mul_u32_u24 v9, 205, v8
    v_lshrrev_b32 v9, 11, v9
    v_mul_u32_u24 v10, 10, v9
    v_sub_u32 v10, v8, v10
    v_mul_u32_u24 v9, 1280, v9
    v_lshl_add_u32 v9, v10, 4, v9
    v_add_u32 v146, s36, v9
    v_cmp_gt_u32 vcc, 32, v0
    v_mov_b32 v8, 0x80000000
    s_nop 0
    v_cndmask_b32 v146, v8, v146, vcc
    s_mov_b32 s60, 0xbfb8aa3b
    s_mov_b32 s61, 0xbfb8aa3b
    s_mov_b32 s62, 1.0
    s_mov_b32 s63, 1.0
    s_barrier
    ds_read_b128 v[8:11], v4 offset:0
    ds_read_b128 v[12:15], v3 offset:0
    ds_read_b128 v[16:19], v3 offset:1024
    ds_read_b128 v[20:23], v3 offset:2048
    ds_read_b128 v[24:27], v3 offset:3072
    ds_read_b128 v[28:31], v3 offset:4096
    ds_read_b128 v[32:35], v4 offset:1024
    ds_read_b128 v[36:39], v3 offset:5120
    ds_read_b128 v[40:43], v3 offset:6144
    ds_read_b128 v[44:47], v3 offset:7168
    ds_read_b128 v[48:51], v3 offset:8192
    ds_read_b128 v[52:55], v3 offset:9216
    s_mov_b32 s18, 5
fz_p2_loopS:
    s_waitcnt lgkmcnt(0)
    v_mfma_f32_16x16x32_bf16 v[104:107], v[12:15], v[8:11], v[104:107]
    ds_read_b128 v[56:59], v4 offset:2048
    v_mfma_f32_16x16x32_bf16 v[108:111], v[16:19], v[8:11], v[108:111]
    ds_read_b128 v[60:63], v3 offset:10240
    v_mfma_f32_16x16x32_bf16 v[112:115], v[20:23], v[8:11], v[112:115]
    ds_read_b128 v[64:67], v3 offset:11264
    v_mfma_f32_16x16x32_bf16 v[116:119], v[24:27], v[8:11], v[116:119]
    ds_read_b128 v[68:71], v3 offset:12288
    v_mfma_f32_16x16x32_bf16 v[120:123], v[28:31], v[8:11], v[120:123]
    ds_read_b128 v[72:75], v3 offset:13312
    v_mfma_f32_16x16x32_bf16 v[104:107], v[36:39], v[32:35], v[104:107]
    ds_read_b128 v[76:79], v3 offset:14336
    v_mfma_f32_16x16x32_bf16 v[108:111], v[40:43], v[32:35], v[108:111]
    ds_read_b128 v[80:83], v4 offset:3072
    v_mfma_f32_16x16x32_bf16 v[112:115], v[44:47], v[32:35], v[112:115]
    ds_read_b128 v[84:87], v3 offset:15360
    v_mfma_f32_16x16x32_bf16 v[116:119], v[48:51], v[32:35], v[116:119]
    ds_read_b128 v[88:91], v3 offset:16384
    v_mfma_f32_16x16x32_bf16 v[120:123], v[52:55], v[32:35], v[120:123]
    ds_read_b128 v[92:95], v3 offset:17408
    ds_read_b128 v[96:99], v3 offset:18432
    ds_read_b128 v[100:103], v3 offset:19456
    s_add_u32 s17, s17, 36864
    s_cmp_eq_u32 s17, 147456
    s_cselect_b32 s17, 0, s17
    s_waitcnt lgkmcnt(0)
    v_add_u32 v3, s17, v1
    v_add_u32 v4, s17, v5
    s_cmp_eq_u32 s18, 4
    s_cbranch_scc0 fz_p2_fw_skip
    s_cmp_lg_u32 s3, 0
    s_cbranch_scc1 fz_p2_fw_skip
    s_mov_b32 s83, 20000
fz_pf_f:
    buffer_load_dword v151, v150, s[84:87], 0 offen sc1
    s_waitcnt vmcnt(0)
    v_cmp_ne_u32 vcc, s82, v151
    s_nop 4
    s_and_b32 s36, vcc_lo, 0xffff
    s_cmp_eq_u32 s36, 0
    s_cbranch_scc1 fz_pf_ok_f
    s_sleep 16
    s_sub_u32 s83, s83, 1
    s_cmp_lg_u32 s83, 0
    s_cbranch_scc1 fz_pf_f
fz_pf_ok_f:
fz_p2_fw_skip:
    s_barrier
    v_mfma_f32_16x16x32_bf16 v[104:107], v[60:63], v[56:59], v[104:107]
    ds_read_b128 v[8:11], v4 offset:0
    v_mfma_f32_16x16x32_bf16 v[108:111], v[64:67], v[56:59], v[108:111]
    ds_read_b128 v[12:15], v3 offset:0
    v_mfma_f32_16x16x32_bf16 v[112:115], v[68:71], v[56:59], v[112:115]
    ds_read_b128 v[16:19], v3 offset:1024
    v_mfma_f32_16x16x32_bf16 v[116:119], v[72:75], v[56:59], v[116:119]
    ds_read_b128 v[20:23], v3 offset:2048
    v_mfma_f32_16x16x32_bf16 v[120:123], v[76:79], v[56:59], v[120:123]
    ds_read_b128 v[24:27], v3 offset:3072
    v_mfma_f32_16x16x32_bf16 v[104:107], v[84:87], v[80:83], v[104:107]
    ds_read_b128 v[28:31], v3 offset:4096
    v_mfma_f32_16x16x32_bf16 v[108:111], v[88:91], v[80:83], v[108:111]
    ds_read_b128 v[32:35], v4 offset:1024
    v_mfma_f32_16x16x32_bf16 v[112:115], v[92:95], v[80:83], v[112:115]
    ds_read_b128 v[36:39], v3 offset:5120
    v_mfma_f32_16x16x32_bf16 v[116:119], v[96:99], v[80:83], v[116:119]
    ds_read_b128 v[40:43], v3 offset:6144
    v_mfma_f32_16x16x32_bf16 v[120:123], v[100:103], v[80:83], v[120:123]
    ds_read_b128 v[44:47], v3 offset:7168
    ds_read_b128 v[48:51], v3 offset:8192
    ds_read_b128 v[52:55], v3 offset:9216
    s_sub_u32 s18, s18, 1
    s_cmp_lg_u32 s18, 0
    s_cbranch_scc1 fz_p2_loopS
    s_mov_b32 s18, 12
fz_p2_loopB:
    s_waitcnt lgkmcnt(0)
    v_mfma_f32_16x16x32_bf16 v[124:127], v[12:15], v[8:11], v[124:127]
    ds_read_b128 v[56:59], v4 offset:2048
    v_mfma_f32_16x16x32_bf16 v[128:131], v[16:19], v[8:11], v[128:131]
    ds_read_b128 v[60:63], v3 offset:10240
    v_mfma_f32_16x16x32_bf16 v[132:135], v[20:23], v[8:11], v[132:135]
    ds_read_b128 v[64:67], v3 offset:11264
    v_mfma_f32_16x16x32_bf16 v[136:139], v[24:27], v[8:11], v[136:139]
    ds_read_b128 v[68:71], v3 offset:12288
    v_mfma_f32_16x16x32_bf16 v[140:143], v[28:31], v[8:11], v[140:143]
    ds_read_b128 v[72:75], v3 offset:13312
    v_mfma_f32_16x16x32_bf16 v[124:127], v[36:39], v[32:35], v[124:127]
    ds_read_b128 v[76:79], v3 offset:14336
    v_mfma_f32_16x16x32_bf16 v[128:131], v[40:43], v[32:35], v[128:131]
    ds_read_b128 v[80:83], v4 offset:3072
    v_mfma_f32_16x16x32_bf16 v[132:135], v[44:47], v[32:35], v[132:135]
    ds_read_b128 v[84:87], v3 offset:15360
    v_mfma_f32_16x16x32_bf16 v[136:139], v[48:51], v[32:35], v[136:139]
    ds_read_b128 v[88:91], v3 offset:16384
    v_mfma_f32_16x16x32_bf16 v[140:143], v[52:55], v[32:35], v[140:143]
    ds_read_b128 v[92:95], v3 offset:17408
    ds_read_b128 v[96:99], v3 offset:18432
    ds_read_b128 v[100:103], v3 offset:19456
    s_add_u32 s17, s17, 36864
    s_cmp_eq_u32 s17, 147456
    s_cselect_b32 s17, 0, s17
    s_waitcnt lgkmcnt(0)
    v_add_u32 v3, s17, v1
    v_add_u32 v4, s17, v5
    s_barrier
    v_mfma_f32_16x16x32_bf16 v[124:127], v[60:63], v[56:59], v[124:127]
    ds_read_b128 v[8:11], v4 offset:0
    v_mfma_f32_16x16x32_bf16 v[128:131], v[64:67], v[56:59], v[128:131]
    ds_read_b128 v[12:15], v3 offset:0
    v_mfma_f32_16x16x32_bf16 v[132:135], v[68:71], v[56:59], v[132:135]
    ds_read_b128 v[16:19], v3 offset:1024
    v_mfma_f32_16x16x32_bf16 v[136:139], v[72:75], v[56:59], v[136:139]
    ds_read_b128 v[20:23], v3 offset:2048
    v_mfma_f32_16x16x32_bf16 v[140:143], v[76:79], v[56:59], v[140:143]
    ds_read_b128 v[24:27], v3 offset:3072
    v_mfma_f32_16x16x32_bf16 v[124:127], v[84:87], v[80:83], v[124:127]
    ds_read_b128 v[28:31], v3 offset:4096
    v_mfma_f32_16x16x32_bf16 v[128:131], v[88:91], v[80:83], v[128:131]
    ds_read_b128 v[32:35], v4 offset:1024
    v_mfma_f32_16x16x32_bf16 v[132:135], v[92:95], v[80:83], v[132:135]
    ds_read_b128 v[36:39], v3 offset:5120
    v_mfma_f32_16x16x32_bf16 v[136:139], v[96:99], v[80:83], v[136:139]
    ds_read_b128 v[40:43], v3 offset:6144
    v_mfma_f32_16x16x32_bf16 v[140:143], v[100:103], v[80:83], v[140:143]
    ds_read_b128 v[44:47], v3 offset:7168
    ds_read_b128 v[48:51], v3 offset:8192
    ds_read_b128 v[52:55], v3 offset:9216
    s_sub_u32 s18, s18, 1
    s_cmp_lg_u32 s18, 0
    s_cbranch_scc1 fz_p2_loopB
    s_waitcnt lgkmcnt(0)
    ds_read_b64 v[8:9], v6 offset:0
    ds_read_b64 v[10:11], v6 offset:32
    ds_read_b64 v[12:13], v6 offset:64
    ds_read_b64 v[14:15], v6 offset:96
    ds_read_b64 v[16:17], v6 offset:128
    s_nop 4
    v_pk_mul_f32 v[20:21], v[124:125], s[60:61]
    v_pk_mul_f32 v[22:23], v[126:127], s[60:61]
    v_pk_mul_f32 v[24:25], v[128:129], s[60:61]
    v_pk_mul_f32 v[26:27], v[130:131], s[60:61]
    v_pk_mul_f32 v[28:29], v[132:133], s[60:61]
    v_pk_mul_f32 v[30:31], v[134:135], s[60:61]
    v_pk_mul_f32 v[32:33], v[136:137], s[60:61]
    v_pk_mul_f32 v[34:35], v[138:139], s[60:61]
    v_pk_mul_f32 v[36:37], v[140:141], s[60:61]
    v_pk_mul_f32 v[38:39], v[142:143], s[60:61]
    v_exp_f32 v20, v20
    v_exp_f32 v21, v21
    v_exp_f32 v22, v22
    v_exp_f32 v23, v23
    v_exp_f32 v24, v24
    v_exp_f32 v25, v25
    v_exp_f32 v26, v26
    v_exp_f32 v27, v27
    v_exp_f32 v28, v28
    v_exp_f32 v29, v29
    v_exp_f32 v30, v30
    v_exp_f32 v31, v31
    v_exp_f32 v32, v32
    v_exp_f32 v33, v33
    v_exp_f32 v34, v34
    v_exp_f32 v35, v35
    v_exp_f32 v36, v36
    v_exp_f32 v37, v37
    v_exp_f32 v38, v38
    v_exp_f32 v39, v39
    v_pk_add_f32 v[20:21], v[20:21], s[62:63]
    v_pk_add_f32 v[22:23], v[22:23], s[62:63]
    v_pk_add_f32 v[24:25], v[24:25], s[62:63]
    v_pk_add_f32 v[26:27], v[26:27], s[62:63]
    v_pk_add_f32 v[28:29], v[28:29], s[62:63]
    v_pk_add_f32 v[30:31], v[30:31], s[62:63]
    v_pk_add_f32 v[32:33], v[32:33], s[62:63]
    v_pk_add_f32 v[34:35], v[34:35], s[62:63]
    v_pk_add_f32 v[36:37], v[36:37], s[62:63]
    v_pk_add_f32 v[38:39], v[38:39], s[62:63]
    v_rcp_f32 v20, v20
    v_rcp_f32 v21, v21
    v_rcp_f32 v22, v22
    v_rcp_f32 v23, v23
    v_rcp_f32 v24, v24
    v_rcp_f32 v25, v25
    v_rcp_f32 v26, v26
    v_rcp_f32 v27, v27
    v_rcp_f32 v28, v28
    v_rcp_f32 v29, v29
    v_rcp_f32 v30, v30
    v_rcp_f32 v31, v31
    v_rcp_f32 v32, v32
    v_rcp_f32 v33, v33
    v_rcp_f32 v34, v34
    v_rcp_f32 v35, v35
    v_rcp_f32 v36, v36
    v_rcp_f32 v37, v37
    v_rcp_f32 v38, v38
    v_rcp_f32 v39, v39
    s_waitcnt lgkmcnt(0)
    v_lshlrev_b32 v40, 16, v8
    v_and_b32 v41, 0xffff0000, v8
    v_lshlrev_b32 v42, 16, v9
    v_and_b32 v43, 0xffff0000, v9
    v_pk_mul_f32 v[20:21], v[124:125], v[20:21]
    v_pk_mul_f32 v[22:23], v[126:127], v[22:23]
    v_pk_fma_f32 v[20:21], v[104:105], v[20:21], v[40:41]
    v_pk_fma_f32 v[22:23], v[106:107], v[22:23], v[42:43]
    v_cvt_pk_bf16_f32 v8, v20, v21
    v_cvt_pk_bf16_f32 v9, v22, v23
    ds_write_b64 v6, v[8:9] offset:0
    v_lshlrev_b32 v44, 16, v10
    v_and_b32 v45, 0xffff0000, v10
    v_lshlrev_b32 v46, 16, v11
    v_and_b32 v47, 0xffff0000, v11
    v_pk_mul_f32 v[24:25], v[128:129], v[24:25]
    v_pk_mul_f32 v[26:27], v[130:131], v[26:27]
    v_pk_fma_f32 v[24:25], v[108:109], v[24:25], v[44:45]
    v_pk_fma_f32 v[26:27], v[110:111], v[26:27], v[46:47]
    v_cvt_pk_bf16_f32 v10, v24, v25
    v_cvt_pk_bf16_f32 v11, v26, v27
    ds_write_b64 v6, v[10:11] offset:32
    v_lshlrev_b32 v40, 16, v12
    v_and_b32 v41, 0xffff0000, v12
    v_lshlrev_b32 v42, 16, v13
    v_and_b32 v43, 0xffff0000, v13
    v_pk_mul_f32 v[28:29], v[132:133], v[28:29]
    v_pk_mul_f32 v[30:31], v[134:135], v[30:31]
    v_pk_fma_f32 v[28:29], v[112:113], v[28:29], v[40:41]
    v_pk_fma_f32 v[30:31], v[114:115], v[30:31], v[42:43]
    v_cvt_pk_bf16_f32 v12, v28, v29
    v_cvt_pk_bf16_f32 v13, v30, v31
    ds_write_b64 v6, v[12:13] offset:64
    v_lshlrev_b32 v44, 16, v14
    v_and_b32 v45, 0xffff0000, v14
    v_lshlrev_b32 v46, 16, v15
    v_and_b32 v47, 0xffff0000, v15
    v_pk_mul_f32 v[32:33], v[136:137], v[32:33]
    v_pk_mul_f32 v[34:35], v[138:139], v[34:35]
    v_pk_fma_f32 v[32:33], v[116:117], v[32:33], v[44:45]
    v_pk_fma_f32 v[34:35], v[118:119], v[34:35], v[46:47]
    v_cvt_pk_bf16_f32 v14, v32, v33
    v_cvt_pk_bf16_f32 v15, v34, v35
    ds_write_b64 v6, v[14:15] offset:96
    v_lshlrev_b32 v40, 16, v16
    v_and_b32 v41, 0xffff0000, v16
    v_lshlrev_b32 v42, 16, v17
    v_and_b32 v43, 0xffff0000, v17
    v_pk_mul_f32 v[36:37], v[140:141], v[36:37]
    v_pk_mul_f32 v[38:39], v[142:143], v[38:39]
    v_pk_fma_f32 v[36:37], v[120:121], v[36:37], v[40:41]
    v_pk_fma_f32 v[38:39], v[122:123], v[38:39], v[42:43]
    v_cvt_pk_bf16_f32 v16, v36, v37
    v_cvt_pk_bf16_f32 v17, v38, v39
    ds_write_b64 v6, v[16:17] offset:128
    s_waitcnt lgkmcnt(0)
    ds_read_b128 v[44:47], v7 offset:0
    ds_read_b128 v[48:51], v7 offset:1024
    ds_read_b128 v[52:55], v7 offset:2048
    s_waitcnt lgkmcnt(2)
    buffer_store_dwordx4 v[44:47], v144, s[32:35], 0 offen
    s_waitcnt lgkmcnt(1)
    buffer_store_dwordx4 v[48:51], v145, s[32:35], 0 offen
    s_waitcnt lgkmcnt(0)
    buffer_store_dwordx4 v[52:55], v146, s[32:35], 0 offen
    s_endpgm
fz_p2_lcommon:
    s_waitcnt vmcnt(8)
    s_barrier
    s_add_u32 m0, s42, s43
    s_add_u32 s39, s41, 4096
    buffer_load_dwordx4 v2, s[24:27], s41 offen offset:0 lds
    buffer_load_dwordx4 v2, s[24:27], s41 offen offset:1024 lds
    buffer_load_dwordx4 v2, s[24:27], s41 offen offset:2048 lds
    buffer_load_dwordx4 v2, s[24:27], s41 offen offset:3072 lds
    s_add_u32 m0, m0, 4096
    s_add_u32 s41, s41, 20480
    buffer_load_dwordx4 v2, s[24:27], s39 offen lds
    s_add_u32 s42, s42, 36864
    s_cmp_eq_u32 s42, 147456
    s_cselect_b32 s42, 0, s42
    s_add_u32 m0, s45, s44
    s_add_u32 s45, s45, 36864
    buffer_load_dwordx4 v2, s[20:23], s40 offen offset:0 lds
    buffer_load_dwordx4 v2, s[20:23], s40 offen offset:1024 lds
    buffer_load_dwordx4 v2, s[20:23], s40 offen offset:2048 lds
    buffer_load_dwordx4 v2, s[20:23], s40 offen offset:3072 lds
    s_add_u32 s40, s40, 4096
    s_cmp_eq_u32 s45, 147456
    s_cselect_b32 s45, 0, s45
    s_waitcnt vmcnt(13)
    s_barrier
    s_add_u32 m0, s42, s43
    s_add_u32 s39, s41, 4096
    buffer_load_dwordx4 v2, s[24:27], s41 offen offset:0 lds
    buffer_load_dwordx4 v2, s[24:27], s41 offen offset:1024 lds
    buffer_load_dwordx4 v2, s[24:27], s41 offen offset:2048 lds
    buffer_load_dwordx4 v2, s[24:27], s41 offen offset:3072 lds
    s_add_u32 m0, m0, 4096
    s_add_u32 s41, s41, 20480
    buffer_load_dwordx4 v2, s[24:27], s39 offen lds
    s_add_u32 s42, s42, 36864
    s_cmp_eq_u32 s42, 147456
    s_cselect_b32 s42, 0, s42
    s_add_u32 m0, s45, s44
    s_add_u32 s45, s45, 36864
    buffer_load_dwordx4 v2, s[20:23], s40 offen offset:0 lds
    buffer_load_dwordx4 v2, s[20:23], s40 offen offset:1024 lds
    buffer_load_dwordx4 v2, s[20:23], s40 offen offset:2048 lds
    buffer_load_dwordx4 v2, s[20:23], s40 offen offset:3072 lds
    s_add_u32 s40, s40, 4096
    s_cmp_eq_u32 s45, 147456
    s_cselect_b32 s45, 0, s45
    s_mov_b32 s46, 12
fz_p2_lloop:
    s_waitcnt vmcnt(18)
    s_barrier
    s_add_u32 m0, s42, s43
    s_add_u32 s39, s41, 4096
    buffer_load_dwordx4 v2, s[24:27], s41 offen offset:0 lds
    buffer_load_dwordx4 v2, s[24:27], s41 offen offset:1024 lds
    buffer_load_dwordx4 v2, s[24:27], s41 offen offset:2048 lds
    buffer_load_dwordx4 v2, s[24:27], s41 offen offset:3072 lds
    s_add_u32 m0, m0, 4096
    s_add_u32 s41, s41, 20480
    buffer_load_dwordx4 v2, s[24:27], s39 offen lds
    s_add_u32 s42, s42, 36864
    s_cmp_eq_u32 s42, 147456
    s_cselect_b32 s42, 0, s42
    s_add_u32 m0, s45, s44
    s_add_u32 s45, s45, 36864
    buffer_load_dwordx4 v2, s[20:23], s40 offen offset:0 lds
    buffer_load_dwordx4 v2, s[20:23], s40 offen offset:1024 lds
    buffer_load_dwordx4 v2, s[20:23], s40 offen offset:2048 lds
    buffer_load_dwordx4 v2, s[20:23], s40 offen offset:3072 lds
    s_add_u32 s40, s40, 4096
    s_cmp_eq_u32 s45, 147456
    s_cselect_b32 s45, 0, s45
    s_sub_u32 s46, s46, 1
    s_cmp_lg_u32 s46, 0
    s_cbranch_scc1 fz_p2_lloop
    s_waitcnt vmcnt(18)
    s_barrier
    s_mov_b32 s28, s4
    s_mov_b32 s29, s5
    s_mov_b32 s30, 2621440
    s_mov_b32 s31, 0x00020000
    s_lshl_b32 s36, s15, 6
    s_mul_i32 s36, s36, 1280
    s_mul_i32 s37, s14, 160
    s_add_u32 s36, s36, s37
    s_mul_i32 s37, s3, 192
    v_add_u32 v8, 0, v0
    v_add_u32 v8, s37, v8
    v_mul_u32_u24 v9, 6554, v8
    v_lshrrev_b32 v9, 16, v9
    v_mul_u32_u24 v10, 10, v9
    v_sub_u32 v10, v8, v10
    v_mul_u32_u24 v9, 1280, v9
    v_lshl_add_u32 v9, v10, 4, v9
    v_add_u32 v12, s36, v9
    v_add_u32 v8, 64, v0
    v_add_u32 v8, s37, v8
    v_mul_u32_u24 v9, 6554, v8
    v_lshrrev_b32 v9, 16, v9
    v_mul_u32_u24 v10, 10, v9
    v_sub_u32 v10, v8, v10
    v_mul_u32_u24 v9, 1280, v9
    v_lshl_add_u32 v9, v10, 4, v9
    v_add_u32 v13, s36, v9
    v_add_u32 v8, 128, v0
    v_add_u32 v8, s37, v8
    v_mul_u32_u24 v9, 6554, v8
    v_lshrrev_b32 v9, 16, v9
    v_mul_u32_u24 v10, 10, v9
    v_sub_u32 v10, v8, v10
    v_mul_u32_u24 v9, 1280, v9
    v_lshl_add_u32 v9, v10, 4, v9
    v_add_u32 v14, s36, v9
    s_mul_i32 s37, s3, 3072
    s_add_u32 s37, s37, 147456
    s_mov_b32 m0, s37
    s_nop 0
    buffer_load_dwordx4 v12, s[28:31], 0 offen lds
    s_add_u32 m0, m0, 1024
    s_nop 0
    buffer_load_dwordx4 v13, s[28:31], 0 offen lds
    s_add_u32 m0, m0, 1024
    s_nop 0
    buffer_load_dwordx4 v14, s[28:31], 0 offen lds
    s_waitcnt vmcnt(12)
    s_barrier
    s_waitcnt vmcnt(3)
    s_barrier
    s_waitcnt vmcnt(0)
    s_barrier
    s_endpgm
fz_done:
    s_endpgm
text_end:
    s_endpgm
.section .rodata,"a"
.p2align 6
.amdhsa_kernel recurrent_scan__sliding_local_dilated__dense_activation_silu__prompt_kernel
  .amdhsa_next_free_vgpr 256
  .amdhsa_next_free_sgpr 102
  .amdhsa_accum_offset 256
  .amdhsa_group_segment_fixed_size 0
  .amdhsa_kernarg_size 72
  .amdhsa_user_sgpr_count 2
  .amdhsa_user_sgpr_kernarg_segment_ptr 1
  .amdhsa_system_sgpr_workgroup_id_x 1
.end_amdhsa_kernel
```
